```python
import torch

def _softmax(x, axis=-1):
    return torch.softmax(x, dim=axis)
def _gelu(x):
    return torch.nn.functional.gelu(x, approximate="tanh")
def _silu(x):
    return torch.nn.functional.silu(x)
def _sigmoid(x):
    return torch.sigmoid(x)
def _layernorm(x, axis=-1, eps=1e-5):
    m = x.mean(dim=axis, keepdim=True)
    v = x.var(dim=axis, keepdim=True, unbiased=False)
    return (x - m) / torch.sqrt(v + eps)
def _scatter_add(tgt, idx, src, axis=0):
    return tgt.clone().index_add_(axis, idx, src)
def _segment_sum(src, seg, n):
    out = torch.zeros((n,) + src.shape[1:], dtype=src.dtype)
    return out.index_add_(0, seg, src)
def _pad(x, pw):
    flat = tuple(v for pair in reversed(pw) for v in pair)
    return torch.nn.functional.pad(x, flat)

kernel_name = 'standalone__detection_seg_dino__vision'

def setup_inputs():

    _w = (lambda a: (lambda t: t.to(torch.bfloat16) if t.is_floating_point() else t)(torch.as_tensor(a)))
    H = W = (256 // 2) * 2
    C = 384
    Nq = 16
    sc = C ** -0.5
    return {
        "q": _w((lambda *s: torch.randn(*s, dtype=torch.bfloat16) * 0.05)(1, Nq, C)),
        "f0": _w((lambda *s: torch.randn(*s, dtype=torch.bfloat16) * 0.8)(1, H, W, C)),
        "f1": _w((lambda *s: torch.randn(*s, dtype=torch.bfloat16) * 0.8)(1, H // 2, W // 2, C)),
        "wq": _w((lambda *s: torch.randn(*s, dtype=torch.bfloat16) * 1.6)(C, C) * sc),
        "wk": _w((lambda *s: torch.randn(*s, dtype=torch.bfloat16) * 1.6)(C, C) * sc),
        "wv": _w((lambda *s: torch.randn(*s, dtype=torch.bfloat16) * 0.8)(C, C) * sc),
        "wo": _w((lambda *s: torch.randn(*s, dtype=torch.bfloat16) * 0.8)(C, C) * sc),
    }

def reference(q, f0, f1, wq, wk, wv, wo):
    B, H, W, C = f0.shape
    f1u = (lambda x, n, axis: torch.repeat_interleave(x, n, dim=axis))((lambda x, n, axis: torch.repeat_interleave(x, n, dim=axis))(f1, 2, axis=1), 2, axis=2)
    fused = f0 + f1u
    feats = _layernorm(fused.reshape(B, H * W, C), axis=-1)
    qn = _layernorm(q, axis=-1)
    Q = torch.einsum("bnc,cd->bnd", qn, wq)
    K = torch.einsum("bmc,cd->bmd", feats, wk)
    V = torch.einsum("bmc,cd->bmd", feats, wv)
    scale = C ** -0.5
    logits = torch.einsum("bnd,bmd->bnm", Q, K) * scale
    attn = _softmax(logits, axis=-1)
    ctx = torch.einsum("bnm,bmd->bnd", attn, V)
    return q + torch.einsum("bnd,dc->bnc", ctx, wo)
```

```asm
; @launch grid=(256,1,1) block=(512,1,1) lds=163840
.amdgcn_target "amdgcn-amd-amdhsa--gfx950"
.text
.globl standalone__detection_seg_dino__vision_kernel
.p2align 8
.type standalone__detection_seg_dino__vision_kernel,@function
standalone__detection_seg_dino__vision_kernel:
    s_cmp_ge_u32 s2, 256
    s_cbranch_scc1 L_main_end
    s_load_dwordx16 s[4:19], s[0:1], 0
    s_load_dwordx4 s[20:23], s[0:1], 64
    v_lshrrev_b32 v1, 6, v0
    v_and_b32 v0, 63, v0
    s_nop 0
    v_readfirstlane_b32 s3, v1
    s_mov_b32 s62, 0x40000
    s_mov_b32 s55, 0x4000
    s_cmp_lt_u32 s3, 4
    s_cbranch_scc1 L_near_c
    s_cmp_eq_u32 s3, 4
    s_cbranch_scc1 L_near_l
    s_cmp_lg_u32 s3, 5
    s_cbranch_scc1 L_near_h1
    v_mov_b32 v2, 0
    v_mov_b32 v3, 0
    v_lshlrev_b32 v1, 3, v0
    v_add_u32 v1, 159744, v1
    ds_write_b64 v1, v[2:3]
    s_waitcnt lgkmcnt(0)
L_near_h1:
    s_cmp_lg_u32 s3, 6
    s_cbranch_scc1 L_near_h2
    s_getpc_b64 s[42:43]
L_pc_1:
    s_sub_u32 s42, s42, L_pc_1-standalone__detection_seg_dino__vision_kernel
    s_subb_u32 s43, s43, 0
    s_bfe_u32 s44, s2, 0x30003
    s_mul_i32 s44, s44, 6144
    v_lshlrev_b32 v2, 4, v0
    v_add_u32 v2, s44, v2
    v_min_u32 v2, L_code_end-standalone__detection_seg_dino__vision_kernel-16, v2
    v_mov_b32 v5, s43
    v_add_co_u32 v4, vcc, s42, v2
    s_nop 1
    v_addc_co_u32 v5, vcc, 0, v5, vcc
    global_load_dwordx4 v[16:19], v[4:5], off
    v_add_u32 v2, 1024, v2
    v_min_u32 v2, L_code_end-standalone__detection_seg_dino__vision_kernel-16, v2
    v_mov_b32 v5, s43
    v_add_co_u32 v4, vcc, s42, v2
    s_nop 1
    v_addc_co_u32 v5, vcc, 0, v5, vcc
    global_load_dwordx4 v[20:23], v[4:5], off
    v_add_u32 v2, 1024, v2
    v_min_u32 v2, L_code_end-standalone__detection_seg_dino__vision_kernel-16, v2
    v_mov_b32 v5, s43
    v_add_co_u32 v4, vcc, s42, v2
    s_nop 1
    v_addc_co_u32 v5, vcc, 0, v5, vcc
    global_load_dwordx4 v[24:27], v[4:5], off
    v_add_u32 v2, 1024, v2
    v_min_u32 v2, L_code_end-standalone__detection_seg_dino__vision_kernel-16, v2
    v_mov_b32 v5, s43
    v_add_co_u32 v4, vcc, s42, v2
    s_nop 1
    v_addc_co_u32 v5, vcc, 0, v5, vcc
    global_load_dwordx4 v[28:31], v[4:5], off
    v_add_u32 v2, 1024, v2
    v_min_u32 v2, L_code_end-standalone__detection_seg_dino__vision_kernel-16, v2
    v_mov_b32 v5, s43
    v_add_co_u32 v4, vcc, s42, v2
    s_nop 1
    v_addc_co_u32 v5, vcc, 0, v5, vcc
    global_load_dwordx4 v[32:35], v[4:5], off
    v_add_u32 v2, 1024, v2
    v_min_u32 v2, L_code_end-standalone__detection_seg_dino__vision_kernel-16, v2
    v_mov_b32 v5, s43
    v_add_co_u32 v4, vcc, s42, v2
    s_nop 1
    v_addc_co_u32 v5, vcc, 0, v5, vcc
    global_load_dwordx4 v[36:39], v[4:5], off
L_near_h2:
    s_barrier
    s_cmp_eq_u32 s3, 7
    s_cbranch_scc1 L_main_poller
    s_branch L_main_spill
L_near_l:
    s_lshr_b32 s42, s2, 3
    s_and_b32 s43, s2, 7
    s_mul_i32 s40, s42, 393216
    s_mul_i32 s44, s43, 24576
    s_add_u32 s40, s40, s44
    s_mul_i32 s41, s42, 98304
    s_mul_i32 s44, s43, 12288
    s_add_u32 s41, s41, s44
    v_lshrrev_b32 v1, 4, v0
    v_and_b32 v2, 15, v0
    v_add_u32 v3, 0, v1
    v_lshlrev_b32 v4, 1, v3
    v_xor_b32 v4, v4, v2
    v_and_b32 v4, 15, v4
    v_lshlrev_b32 v4, 4, v4
    v_mul_u32_u24 v5, 768, v3
    v_add_u32 v10, v5, v4
    v_mul_u32_u24 v5, 1536, v3
    v_add_u32 v12, v5, v4
    v_add_u32 v3, 4, v1
    v_lshlrev_b32 v4, 1, v3
    v_xor_b32 v4, v4, v2
    v_and_b32 v4, 15, v4
    v_lshlrev_b32 v4, 4, v4
    v_mul_u32_u24 v5, 768, v3
    v_add_u32 v11, v5, v4
    v_mul_u32_u24 v5, 1536, v3
    v_add_u32 v13, v5, v4
    v_mov_b32 v15, 159744
    s_waitcnt lgkmcnt(0)
    s_load_dword s54, s[22:23], 0
    s_mov_b32 s24, s6
    s_and_b32 s25, s7, 0xffff
    s_mov_b32 s26, 50331648
    s_mov_b32 s27, 0x20000
    s_mov_b32 s28, s8
    s_and_b32 s29, s9, 0xffff
    s_mov_b32 s30, 12582912
    s_mov_b32 s31, 0x20000
    s_mov_b32 s32, s22
    s_and_b32 s33, s23, 0xffff
    s_mov_b32 s34, 268435456
    s_mov_b32 s35, 0x20000
    s_cmp_ge_u32 s2, 6
    s_cbranch_scc1 L_nohold_2
    s_barrier
L_spin_3:
    ds_read_b128 v[16:19], v15 offset:224
    s_waitcnt lgkmcnt(0)
    v_min3_u32 v16, v16, v17, v18
    v_min_u32 v16, v16, v19
    s_nop 0
    v_readfirstlane_b32 s61, v16
    s_nop 0
    s_cmp_ge_u32 s61, 1
    s_cbranch_scc0 L_retry_5
L_done_4:
L_nohold_2:
    s_mov_b32 m0, 0
    s_add_u32 s44, s41, 0
    buffer_load_dwordx4 v10, s[28:31], s44 offen nt lds
    s_mov_b32 m0, 1024
    s_add_u32 s44, s41, 0
    buffer_load_dwordx4 v11, s[28:31], s44 offen nt lds
    s_mov_b32 m0, 2048
    s_add_u32 s44, s41, 6144
    buffer_load_dwordx4 v10, s[28:31], s44 offen nt lds
    s_mov_b32 m0, 3072
    s_add_u32 s44, s41, 6144
    buffer_load_dwordx4 v11, s[28:31], s44 offen nt lds
    s_mov_b32 m0, 12288
    s_add_u32 s44, s41, 3145728
    buffer_load_dwordx4 v10, s[28:31], s44 offen nt lds
    s_mov_b32 m0, 13312
    s_add_u32 s44, s41, 3145728
    buffer_load_dwordx4 v11, s[28:31], s44 offen nt lds
    s_mov_b32 m0, 14336
    s_add_u32 s44, s41, 3151872
    buffer_load_dwordx4 v10, s[28:31], s44 offen nt lds
    s_mov_b32 m0, 15360
    s_add_u32 s44, s41, 3151872
    buffer_load_dwordx4 v11, s[28:31], s44 offen nt lds
    s_mov_b32 m0, 24576
    s_add_u32 s44, s41, 6291456
    buffer_load_dwordx4 v10, s[28:31], s44 offen nt lds
    s_mov_b32 m0, 25600
    s_add_u32 s44, s41, 6291456
    buffer_load_dwordx4 v11, s[28:31], s44 offen nt lds
    s_mov_b32 m0, 26624
    s_add_u32 s44, s41, 6297600
    buffer_load_dwordx4 v10, s[28:31], s44 offen nt lds
    s_mov_b32 m0, 27648
    s_add_u32 s44, s41, 6297600
    buffer_load_dwordx4 v11, s[28:31], s44 offen nt lds
    s_mov_b32 m0, 36864
    s_add_u32 s44, s41, 9437184
    buffer_load_dwordx4 v10, s[28:31], s44 offen nt lds
    s_mov_b32 m0, 37888
    s_add_u32 s44, s41, 9437184
    buffer_load_dwordx4 v11, s[28:31], s44 offen nt lds
    s_mov_b32 m0, 38912
    s_add_u32 s44, s41, 9443328
    buffer_load_dwordx4 v10, s[28:31], s44 offen nt lds
    s_mov_b32 m0, 39936
    s_add_u32 s44, s41, 9443328
    buffer_load_dwordx4 v11, s[28:31], s44 offen nt lds
    s_mov_b32 m0, 4096
    s_add_u32 s44, s41, 256
    buffer_load_dwordx4 v10, s[28:31], s44 offen nt lds
    s_mov_b32 m0, 5120
    s_add_u32 s44, s41, 256
    buffer_load_dwordx4 v11, s[28:31], s44 offen nt lds
    s_cmp_lt_u32 s2, 6
    s_cbranch_scc1 L_main_loader
    s_barrier
    s_branch L_main_loader
L_near_c:
    s_waitcnt lgkmcnt(0)
    s_load_dword s54, s[22:23], 0
    s_mov_b32 s24, s6
    s_and_b32 s25, s7, 0xffff
    s_mov_b32 s26, 50331648
    s_mov_b32 s27, 0x20000
    s_mov_b32 s28, s8
    s_and_b32 s29, s9, 0xffff
    s_mov_b32 s30, 12582912
    s_mov_b32 s31, 0x20000
    s_mov_b32 s32, s22
    s_and_b32 s33, s23, 0xffff
    s_mov_b32 s34, 268435456
    s_mov_b32 s35, 0x20000
    s_mov_b32 s63, 0
    s_cmp_ge_u32 s2, 6
    s_cbranch_scc1 L_norole_7
    s_cmp_gt_u32 s3, 3
    s_cbranch_scc1 L_issued_6
    s_mov_b32 s63, 1
    s_mov_b32 s36, s10
    s_and_b32 s37, s11, 0xffff
    s_mov_b32 s38, 294912
    s_mov_b32 s39, 0x20000
    s_mov_b32 s56, s4
    s_and_b32 s57, s5, 0xffff
    s_mov_b32 s58, 12288
    s_mov_b32 s59, 0x20000
    s_mov_b32 s40, 0
    s_lshl_b32 s41, s2, 7
    v_lshrrev_b32 v1, 4, v0
    v_and_b32 v2, 15, v0
    v_add_u32 v3, 0, v1
    v_lshlrev_b32 v4, 1, v3
    v_xor_b32 v4, v4, v2
    v_and_b32 v4, 15, v4
    v_lshlrev_b32 v4, 4, v4
    v_mul_u32_u24 v5, 768, v3
    v_add_u32 v40, v5, v4
    v_add_u32 v3, 4, v1
    v_lshlrev_b32 v4, 1, v3
    v_xor_b32 v4, v4, v2
    v_and_b32 v4, 15, v4
    v_lshlrev_b32 v4, 4, v4
    v_mul_u32_u24 v5, 768, v3
    v_add_u32 v41, v5, v4
    s_cmp_eq_u32 s3, 3
    s_cbranch_scc1 L_noq_8
    s_lshl_b32 s45, s3, 8
    s_add_u32 s45, s45, s40
    s_lshl_b32 s46, s3, 12
    s_add_u32 s46, s46, 147456
    s_add_u32 m0, s46, 0
    s_add_u32 s44, s45, 0
    buffer_load_dwordx4 v40, s[56:59], s44 offen lds
    s_add_u32 m0, s46, 1024
    s_add_u32 s44, s45, 0
    buffer_load_dwordx4 v41, s[56:59], s44 offen lds
    s_add_u32 m0, s46, 2048
    s_add_u32 s44, s45, 6144
    buffer_load_dwordx4 v40, s[56:59], s44 offen lds
    s_add_u32 m0, s46, 3072
    s_add_u32 s44, s45, 6144
    buffer_load_dwordx4 v41, s[56:59], s44 offen lds
L_noq_8:
    v_lshrrev_b32 v3, 3, v0
    v_mul_u32_u24 v42, 768, v3
    v_bfe_u32 v3, v0, 4, 1
    v_lshlrev_b32 v3, 1, v3
    v_and_b32 v4, 7, v0
    v_xor_b32 v3, v3, v4
    v_lshlrev_b32 v4, 4, v3
    v_add_u32 v42, v42, v4
    v_xor_b32 v3, 4, v3
    v_lshlrev_b32 v3, 4, v3
    v_sub_u32 v3, v3, v4
    v_add_u32 v43, v42, v3
    v_lshrrev_b32 v3, 4, v0
    v_lshlrev_b32 v9, 10, v3
    v_bfe_u32 v4, v0, 2, 2
    v_lshlrev_b32 v4, 7, v4
    v_add_u32 v9, v9, v4
    v_and_b32 v4, 3, v0
    v_lshlrev_b32 v4, 3, v4
    v_add_u32 v9, v9, v4
    v_add_u32 v9, 98304, v9
    v_bfe_u32 v3, v0, 3, 2
    v_mov_b32 v8, v3
    s_mul_i32 s45, s3, 12288
    s_add_u32 s45, s45, 98304
    s_mul_i32 s46, s3, 73728
    s_add_u32 s46, s46, s41
    s_add_u32 m0, s45, 0
    s_add_u32 s44, s46, 0
    buffer_load_dwordx4 v42, s[36:39], s44 offen lds
    s_add_u32 m0, s45, 1024
    s_add_u32 s44, s46, 6144
    buffer_load_dwordx4 v43, s[36:39], s44 offen lds
    s_add_u32 m0, s45, 2048
    s_add_u32 s44, s46, 12288
    buffer_load_dwordx4 v42, s[36:39], s44 offen lds
    s_add_u32 m0, s45, 3072
    s_add_u32 s44, s46, 18432
    buffer_load_dwordx4 v43, s[36:39], s44 offen lds
    s_add_u32 m0, s45, 4096
    s_add_u32 s44, s46, 24576
    buffer_load_dwordx4 v42, s[36:39], s44 offen lds
    s_add_u32 m0, s45, 5120
    s_add_u32 s44, s46, 30720
    buffer_load_dwordx4 v43, s[36:39], s44 offen lds
    s_add_u32 m0, s45, 6144
    s_add_u32 s44, s46, 36864
    buffer_load_dwordx4 v42, s[36:39], s44 offen lds
    s_add_u32 m0, s45, 7168
    s_add_u32 s44, s46, 43008
    buffer_load_dwordx4 v43, s[36:39], s44 offen lds
    s_add_u32 m0, s45, 8192
    s_add_u32 s44, s46, 49152
    buffer_load_dwordx4 v42, s[36:39], s44 offen lds
    s_add_u32 m0, s45, 9216
    s_add_u32 s44, s46, 55296
    buffer_load_dwordx4 v43, s[36:39], s44 offen lds
    s_add_u32 m0, s45, 10240
    s_add_u32 s44, s46, 61440
    buffer_load_dwordx4 v42, s[36:39], s44 offen lds
    s_add_u32 m0, s45, 11264
    s_add_u32 s44, s46, 67584
    buffer_load_dwordx4 v43, s[36:39], s44 offen lds
    s_branch L_issued_6
L_norole_7:
    s_cmp_lt_u32 s2, 8
    s_cbranch_scc1 L_norole_9
    s_cmp_ge_u32 s2, 32
    s_cbranch_scc1 L_norole_9
    s_cmp_gt_u32 s3, 0
    s_cbranch_scc1 L_issued_6
    s_mov_b32 s63, 2
    s_mov_b32 s36, s12
    s_and_b32 s37, s13, 0xffff
    s_mov_b32 s38, 294912
    s_mov_b32 s39, 0x20000
    v_and_b32 v3, 15, v0
    v_mul_u32_u24 v7, 768, v3
    v_lshrrev_b32 v3, 4, v0
    v_lshlrev_b32 v3, 4, v3
    v_add_u32 v7, v7, v3
    s_sub_u32 s45, s2, 8
    s_mul_i32 s40, s45, 12288
    buffer_load_dwordx4 v[40:43], v7, s[36:39], s40 offen offset:0
    buffer_load_dwordx4 v[44:47], v7, s[36:39], s40 offen offset:64
    buffer_load_dwordx4 v[48:51], v7, s[36:39], s40 offen offset:128
    buffer_load_dwordx4 v[52:55], v7, s[36:39], s40 offen offset:192
    buffer_load_dwordx4 v[56:59], v7, s[36:39], s40 offen offset:256
    buffer_load_dwordx4 v[60:63], v7, s[36:39], s40 offen offset:320
    buffer_load_dwordx4 v[64:67], v7, s[36:39], s40 offen offset:384
    buffer_load_dwordx4 v[68:71], v7, s[36:39], s40 offen offset:448
    buffer_load_dwordx4 v[72:75], v7, s[36:39], s40 offen offset:512
    buffer_load_dwordx4 v[76:79], v7, s[36:39], s40 offen offset:576
    buffer_load_dwordx4 v[80:83], v7, s[36:39], s40 offen offset:640
    buffer_load_dwordx4 v[84:87], v7, s[36:39], s40 offen offset:704
    s_branch L_issued_6
L_norole_9:
L_issued_6:
    s_barrier
    s_cmp_lt_u32 s2, 32
    s_cbranch_scc1 L_norole_11
    s_cmp_ge_u32 s2, 176
    s_cbranch_scc1 L_norole_11
    s_cmp_gt_u32 s3, 3
    s_cbranch_scc1 L_issued_10
    s_mov_b32 s63, 3
    s_mov_b32 s36, s16
    s_and_b32 s37, s17, 0xffff
    s_mov_b32 s38, 294912
    s_mov_b32 s39, 0x20000
    s_mov_b32 s56, s14
    s_and_b32 s57, s15, 0xffff
    s_mov_b32 s58, 294912
    s_mov_b32 s59, 0x20000
    s_sub_u32 s41, s2, 32
    s_mul_i32 s40, s41, 10923
    s_lshr_b32 s40, s40, 16
    s_mul_i32 s42, s40, 6
    s_sub_u32 s41, s41, s42
    s_mul_i32 s40, s40, 12288
    s_lshl_b32 s41, s41, 7
    v_lshrrev_b32 v1, 4, v0
    v_and_b32 v2, 15, v0
    v_add_u32 v3, 0, v1
    v_lshlrev_b32 v4, 1, v3
    v_xor_b32 v4, v4, v2
    v_and_b32 v4, 15, v4
    v_lshlrev_b32 v4, 4, v4
    v_mul_u32_u24 v5, 768, v3
    v_add_u32 v40, v5, v4
    v_add_u32 v3, 4, v1
    v_lshlrev_b32 v4, 1, v3
    v_xor_b32 v4, v4, v2
    v_and_b32 v4, 15, v4
    v_lshlrev_b32 v4, 4, v4
    v_mul_u32_u24 v5, 768, v3
    v_add_u32 v41, v5, v4
    s_cmp_eq_u32 s3, 3
    s_cbranch_scc1 L_noq_12
    s_lshl_b32 s45, s3, 8
    s_add_u32 s45, s45, s40
    s_lshl_b32 s46, s3, 12
    s_add_u32 s46, s46, 147456
    s_add_u32 m0, s46, 0
    s_add_u32 s44, s45, 0
    buffer_load_dwordx4 v40, s[56:59], s44 offen lds
    s_add_u32 m0, s46, 1024
    s_add_u32 s44, s45, 0
    buffer_load_dwordx4 v41, s[56:59], s44 offen lds
    s_add_u32 m0, s46, 2048
    s_add_u32 s44, s45, 6144
    buffer_load_dwordx4 v40, s[56:59], s44 offen lds
    s_add_u32 m0, s46, 3072
    s_add_u32 s44, s45, 6144
    buffer_load_dwordx4 v41, s[56:59], s44 offen lds
L_noq_12:
    v_lshrrev_b32 v3, 3, v0
    v_mul_u32_u24 v42, 768, v3
    v_bfe_u32 v3, v0, 4, 1
    v_lshlrev_b32 v3, 1, v3
    v_and_b32 v4, 7, v0
    v_xor_b32 v3, v3, v4
    v_lshlrev_b32 v4, 4, v3
    v_add_u32 v42, v42, v4
    v_xor_b32 v3, 4, v3
    v_lshlrev_b32 v3, 4, v3
    v_sub_u32 v3, v3, v4
    v_add_u32 v43, v42, v3
    v_lshrrev_b32 v3, 4, v0
    v_lshlrev_b32 v9, 10, v3
    v_bfe_u32 v4, v0, 2, 2
    v_lshlrev_b32 v4, 7, v4
    v_add_u32 v9, v9, v4
    v_and_b32 v4, 3, v0
    v_lshlrev_b32 v4, 3, v4
    v_add_u32 v9, v9, v4
    v_add_u32 v9, 98304, v9
    v_bfe_u32 v3, v0, 3, 2
    v_mov_b32 v8, v3
    s_mul_i32 s45, s3, 12288
    s_add_u32 s45, s45, 98304
    s_mul_i32 s46, s3, 73728
    s_add_u32 s46, s46, s41
    s_add_u32 m0, s45, 0
    s_add_u32 s44, s46, 0
    buffer_load_dwordx4 v42, s[36:39], s44 offen lds
    s_add_u32 m0, s45, 1024
    s_add_u32 s44, s46, 6144
    buffer_load_dwordx4 v43, s[36:39], s44 offen lds
    s_add_u32 m0, s45, 2048
    s_add_u32 s44, s46, 12288
    buffer_load_dwordx4 v42, s[36:39], s44 offen lds
    s_add_u32 m0, s45, 3072
    s_add_u32 s44, s46, 18432
    buffer_load_dwordx4 v43, s[36:39], s44 offen lds
    s_add_u32 m0, s45, 4096
    s_add_u32 s44, s46, 24576
    buffer_load_dwordx4 v42, s[36:39], s44 offen lds
    s_add_u32 m0, s45, 5120
    s_add_u32 s44, s46, 30720
    buffer_load_dwordx4 v43, s[36:39], s44 offen lds
    s_add_u32 m0, s45, 6144
    s_add_u32 s44, s46, 36864
    buffer_load_dwordx4 v42, s[36:39], s44 offen lds
    s_add_u32 m0, s45, 7168
    s_add_u32 s44, s46, 43008
    buffer_load_dwordx4 v43, s[36:39], s44 offen lds
    s_add_u32 m0, s45, 8192
    s_add_u32 s44, s46, 49152
    buffer_load_dwordx4 v42, s[36:39], s44 offen lds
    s_add_u32 m0, s45, 9216
    s_add_u32 s44, s46, 55296
    buffer_load_dwordx4 v43, s[36:39], s44 offen lds
    s_add_u32 m0, s45, 10240
    s_add_u32 s44, s46, 61440
    buffer_load_dwordx4 v42, s[36:39], s44 offen lds
    s_add_u32 m0, s45, 11264
    s_add_u32 s44, s46, 67584
    buffer_load_dwordx4 v43, s[36:39], s44 offen lds
    s_branch L_issued_10
L_norole_11:
L_issued_10:
    s_lshl_b32 s42, s3, 2
    s_add_u32 s42, s42, 159744
    v_mov_b32 v1, s42
    v_mov_b32 v2, 1
    ds_write_b32 v1, v2 offset:224
    v_and_b32 v1, 15, v0
    v_lshrrev_b32 v2, 4, v0
    s_mul_i32 s40, s3, 12288
    v_and_b32 v3, 7, v1
    v_lshlrev_b32 v3, 1, v3
    v_lshlrev_b32 v4, 8, v1
    v_add_u32 v4, s40, v4
    v_add_u32 v5, 0, v2
    v_xor_b32 v5, v5, v3
    v_lshlrev_b32 v5, 4, v5
    v_add_u32 v10, v4, v5
    v_add_u32 v5, 4, v2
    v_xor_b32 v5, v5, v3
    v_lshlrev_b32 v5, 4, v5
    v_add_u32 v11, v4, v5
    v_add_u32 v5, 8, v2
    v_xor_b32 v5, v5, v3
    v_lshlrev_b32 v5, 4, v5
    v_add_u32 v12, v4, v5
    v_add_u32 v5, 12, v2
    v_xor_b32 v5, v5, v3
    v_lshlrev_b32 v5, 4, v5
    v_add_u32 v13, v4, v5
    v_bfe_u32 v3, v0, 2, 2
    v_lshlrev_b32 v4, 2, v2
    v_add_u32 v3, v3, v4
    v_and_b32 v4, 7, v3
    v_lshlrev_b32 v5, 8, v3
    v_bfe_u32 v6, v0, 1, 1
    v_lshlrev_b32 v6, 4, v6
    v_add_u32 v5, v5, v6
    v_and_b32 v6, 1, v0
    v_lshlrev_b32 v6, 3, v6
    v_add_u32 v5, v5, v6
    s_mul_i32 s41, s3, 6
    s_add_u32 s42, s41, 0
    s_and_b32 s43, s42, 7
    s_lshr_b32 s42, s42, 3
    s_lshl_b32 s42, s42, 12
    v_xor_b32 v6, s43, v4
    v_lshlrev_b32 v6, 5, v6
    v_add_u32 v6, v6, v5
    v_add_u32 v14, s42, v6
    s_add_u32 s42, s41, 1
    s_and_b32 s43, s42, 7
    s_lshr_b32 s42, s42, 3
    s_lshl_b32 s42, s42, 12
    v_xor_b32 v6, s43, v4
    v_lshlrev_b32 v6, 5, v6
    v_add_u32 v6, v6, v5
    v_add_u32 v15, s42, v6
    s_add_u32 s42, s41, 2
    s_and_b32 s43, s42, 7
    s_lshr_b32 s42, s42, 3
    s_lshl_b32 s42, s42, 12
    v_xor_b32 v6, s43, v4
    v_lshlrev_b32 v6, 5, v6
    v_add_u32 v6, v6, v5
    v_add_u32 v16, s42, v6
    s_add_u32 s42, s41, 3
    s_and_b32 s43, s42, 7
    s_lshr_b32 s42, s42, 3
    s_lshl_b32 s42, s42, 12
    v_xor_b32 v6, s43, v4
    v_lshlrev_b32 v6, 5, v6
    v_add_u32 v6, v6, v5
    v_add_u32 v17, s42, v6
    s_add_u32 s42, s41, 4
    s_and_b32 s43, s42, 7
    s_lshr_b32 s42, s42, 3
    s_lshl_b32 s42, s42, 12
    v_xor_b32 v6, s43, v4
    v_lshlrev_b32 v6, 5, v6
    v_add_u32 v6, v6, v5
    v_add_u32 v18, s42, v6
    s_add_u32 s42, s41, 5
    s_and_b32 s43, s42, 7
    s_lshr_b32 s42, s42, 3
    s_lshl_b32 s42, s42, 12
    v_xor_b32 v6, s43, v4
    v_lshlrev_b32 v6, 5, v6
    v_add_u32 v6, v6, v5
    v_add_u32 v19, s42, v6
    s_lshl_b32 s42, s3, 9
    s_add_u32 s42, s42, 147456
    v_lshlrev_b32 v3, 3, v0
    v_add_u32 v20, s42, v3
    v_add_u32 v21, 147456, v3
    v_lshlrev_b32 v3, 4, v1
    v_add_u32 v23, 161792, v3
    s_lshl_b32 s42, s3, 2
    v_add_u32 v22, s42, v23
    v_mov_b32 v24, 159744
    v_add_u32 v25, s42, v24
    s_lshr_b32 s42, s3, 1
    s_lshl_b32 s42, s42, 2
    v_add_u32 v27, s42, v24
    v_mov_b32 v36, 0x3f803f80
    v_mov_b32 v37, 0x3f803f80
    v_mov_b32 v38, 0x3f803f80
    v_mov_b32 v39, 0x3f803f80
    v_and_b32 v3, 3, v0
    v_cmp_eq_u32 s[4:5], 1, v3
    v_cmp_eq_u32 s[6:7], 2, v3
    v_cmp_eq_u32 s[8:9], 3, v3
    s_mov_b32 s52, 992651947
    s_mov_b32 s53, 992651947
    s_mov_b32 s96, 2.0
    s_mov_b32 s97, 2.0
    s_mov_b32 s98, 925353388
    s_mov_b32 s99, 1103101952
    s_waitcnt lgkmcnt(0)
    s_add_u32 s54, s54, 1
    s_and_b32 s61, s54, 0xffff
    s_cmp_eq_u32 s61, 0
    s_addc_u32 s54, s54, 0
    s_cmp_eq_u32 s63, 0
    s_cbranch_scc1 L_rolenone_14
    s_cmp_lg_u32 s63, 1
    s_cbranch_scc1 L_notthis_15
    v_and_b32 v6, 15, v0
    v_lshrrev_b32 v3, 2, v6
    v_lshlrev_b32 v3, 4, v3
    v_add_u32 v6, v6, v3
    v_lshlrev_b32 v6, 2, v6
    v_xor_b32 v7, s3, v8
    v_lshlrev_b32 v7, 5, v7
    v_add_u32 v7, v7, v9
    s_lshl_b32 s45, s2, 2
    s_add_u32 s45, s45, s3
    s_lshr_b32 s42, s45, 1
    s_lshl_b32 s42, s42, 10
    s_and_b32 s43, s45, 1
    s_lshl_b32 s43, s43, 9
    s_add_u32 s42, s42, s43
    v_and_b32 v30, 15, v0
    v_lshlrev_b32 v30, 4, v30
    v_lshrrev_b32 v4, 5, v0
    v_lshlrev_b32 v4, 8, v4
    v_add_u32 v30, v30, v4
    v_bfe_u32 v4, v0, 4, 1
    v_lshlrev_b32 v4, 3, v4
    v_add_u32 v30, v30, v4
    v_add_u32 v30, s42, v30
    s_lshr_b32 s42, s45, 1
    s_lshl_b32 s42, s42, 8
    s_and_b32 s43, s45, 1
    s_lshl_b32 s43, s43, 7
    s_add_u32 s43, s43, s42
    s_add_u32 s46, s43, 16384
    v_and_b32 v31, 15, v0
    v_lshlrev_b32 v31, 2, v31
    v_lshrrev_b32 v4, 5, v0
    v_lshlrev_b32 v4, 6, v4
    v_add_u32 v31, v31, v4
    s_waitcnt vmcnt(12)
    v_mov_b32 v4, 1
    ds_write_b32 v25, v4 offset:288
L_spin_16:
    ds_read_b128 v[2:5], v24 offset:288
    s_waitcnt lgkmcnt(0)
    v_min3_u32 v2, v2, v3, v4
    v_min_u32 v2, v2, v5
    s_nop 0
    v_readfirstlane_b32 s61, v2
    s_nop 0
    s_cmp_ge_u32 s61, 1
    s_cbranch_scc0 L_retry_18
L_done_17:
    s_mul_i32 s40, s3, 12288
    s_sub_u32 s40, 147456, s40
    v_add_u32 v144, s40, v10
    v_add_u32 v145, s40, v11
    v_add_u32 v146, s40, v12
    v_add_u32 v147, s40, v13
    ds_read_b128 v[40:43], v144 offset:0
    ds_read_b128 v[44:47], v145 offset:0
    ds_read_b128 v[48:51], v146 offset:0
    ds_read_b128 v[52:55], v147 offset:0
    ds_read_b128 v[56:59], v144 offset:4096
    ds_read_b128 v[60:63], v145 offset:4096
    ds_read_b128 v[64:67], v146 offset:4096
    ds_read_b128 v[68:71], v147 offset:4096
    ds_read_b128 v[72:75], v144 offset:8192
    ds_read_b128 v[76:79], v145 offset:8192
    ds_read_b128 v[80:83], v146 offset:8192
    ds_read_b128 v[84:87], v147 offset:8192
    s_waitcnt lgkmcnt(11)
    v_mfma_f32_16x16x32_bf16 v[160:163], v[36:39], v[40:43], 0
    v_mfma_f32_16x16x32_bf16 v[164:167], v[40:43], v[40:43], 0
    s_waitcnt lgkmcnt(10)
    v_mfma_f32_16x16x32_bf16 v[160:163], v[36:39], v[44:47], v[160:163]
    v_mfma_f32_16x16x32_bf16 v[164:167], v[44:47], v[44:47], v[164:167]
    s_waitcnt lgkmcnt(9)
    v_mfma_f32_16x16x32_bf16 v[160:163], v[36:39], v[48:51], v[160:163]
    v_mfma_f32_16x16x32_bf16 v[164:167], v[48:51], v[48:51], v[164:167]
    s_waitcnt lgkmcnt(8)
    v_mfma_f32_16x16x32_bf16 v[160:163], v[36:39], v[52:55], v[160:163]
    v_mfma_f32_16x16x32_bf16 v[164:167], v[52:55], v[52:55], v[164:167]
    s_waitcnt lgkmcnt(7)
    v_mfma_f32_16x16x32_bf16 v[160:163], v[36:39], v[56:59], v[160:163]
    v_mfma_f32_16x16x32_bf16 v[164:167], v[56:59], v[56:59], v[164:167]
    s_waitcnt lgkmcnt(6)
    v_mfma_f32_16x16x32_bf16 v[160:163], v[36:39], v[60:63], v[160:163]
    v_mfma_f32_16x16x32_bf16 v[164:167], v[60:63], v[60:63], v[164:167]
    s_waitcnt lgkmcnt(5)
    v_mfma_f32_16x16x32_bf16 v[160:163], v[36:39], v[64:67], v[160:163]
    v_mfma_f32_16x16x32_bf16 v[164:167], v[64:67], v[64:67], v[164:167]
    s_waitcnt lgkmcnt(4)
    v_mfma_f32_16x16x32_bf16 v[160:163], v[36:39], v[68:71], v[160:163]
    v_mfma_f32_16x16x32_bf16 v[164:167], v[68:71], v[68:71], v[164:167]
    s_waitcnt lgkmcnt(3)
    v_mfma_f32_16x16x32_bf16 v[160:163], v[36:39], v[72:75], v[160:163]
    v_mfma_f32_16x16x32_bf16 v[164:167], v[72:75], v[72:75], v[164:167]
    s_waitcnt lgkmcnt(2)
    v_mfma_f32_16x16x32_bf16 v[160:163], v[36:39], v[76:79], v[160:163]
    v_mfma_f32_16x16x32_bf16 v[164:167], v[76:79], v[76:79], v[164:167]
    s_waitcnt lgkmcnt(1)
    v_mfma_f32_16x16x32_bf16 v[160:163], v[36:39], v[80:83], v[160:163]
    v_mfma_f32_16x16x32_bf16 v[164:167], v[80:83], v[80:83], v[164:167]
    s_waitcnt lgkmcnt(0)
    v_mfma_f32_16x16x32_bf16 v[160:163], v[36:39], v[84:87], v[160:163]
    v_mfma_f32_16x16x32_bf16 v[164:167], v[84:87], v[84:87], v[164:167]
    s_nop 7
    v_cndmask_b32 v136, v164, v165, s[4:5]
    v_cndmask_b32 v136, v136, v166, s[6:7]
    v_cndmask_b32 v136, v136, v167, s[8:9]
    ds_bpermute_b32 v137, v6, v136
    v_mul_f32 v138, s52, v160
    v_mul_f32 v139, v138, v138
    s_waitcnt lgkmcnt(0)
    v_fma_f32 v139, v137, s52, -v139
    v_add_f32 v139, s98, abs(v139)
    v_rsq_f32 v139, v139
    s_waitcnt vmcnt(0)
    v_mov_b32 v4, 1
    ds_write_b32 v25, v4 offset:80
L_spin_19:
    ds_read_b128 v[2:5], v24 offset:80
    s_waitcnt lgkmcnt(0)
    v_min3_u32 v2, v2, v3, v4
    v_min_u32 v2, v2, v5
    s_nop 0
    v_readfirstlane_b32 s61, v2
    s_nop 0
    s_cmp_ge_u32 s61, 1
    s_cbranch_scc0 L_retry_21
L_done_20:
    ds_read_b64_tr_b16 v[88:89], v7 offset:0
    ds_read_b64_tr_b16 v[90:91], v7 offset:512
    ds_read_b64_tr_b16 v[92:93], v7 offset:4096
    ds_read_b64_tr_b16 v[94:95], v7 offset:4608
    ds_read_b64_tr_b16 v[96:97], v7 offset:8192
    ds_read_b64_tr_b16 v[98:99], v7 offset:8704
    ds_read_b64_tr_b16 v[100:101], v7 offset:12288
    ds_read_b64_tr_b16 v[102:103], v7 offset:12800
    ds_read_b64_tr_b16 v[104:105], v7 offset:16384
    ds_read_b64_tr_b16 v[106:107], v7 offset:16896
    ds_read_b64_tr_b16 v[108:109], v7 offset:20480
    ds_read_b64_tr_b16 v[110:111], v7 offset:20992
    ds_read_b64_tr_b16 v[112:113], v7 offset:24576
    ds_read_b64_tr_b16 v[114:115], v7 offset:25088
    ds_read_b64_tr_b16 v[116:117], v7 offset:28672
    ds_read_b64_tr_b16 v[118:119], v7 offset:29184
    ds_read_b64_tr_b16 v[120:121], v7 offset:32768
    ds_read_b64_tr_b16 v[122:123], v7 offset:33280
    ds_read_b64_tr_b16 v[124:125], v7 offset:36864
    ds_read_b64_tr_b16 v[126:127], v7 offset:37376
    ds_read_b64_tr_b16 v[128:129], v7 offset:40960
    ds_read_b64_tr_b16 v[130:131], v7 offset:41472
    ds_read_b64_tr_b16 v[132:133], v7 offset:45056
    ds_read_b64_tr_b16 v[134:135], v7 offset:45568
    v_mov_b32 v4, 1
    ds_write_b32 v25, v4 offset:64
    s_waitcnt lgkmcnt(15)
    v_mfma_f32_16x16x32_bf16 v[152:155], v[88:91], v[40:43], 0
    v_mfma_f32_16x16x32_bf16 v[156:159], v[88:91], v[36:39], 0
    v_mfma_f32_16x16x32_bf16 v[152:155], v[92:95], v[44:47], v[152:155]
    v_mfma_f32_16x16x32_bf16 v[156:159], v[92:95], v[36:39], v[156:159]
    v_mfma_f32_16x16x32_bf16 v[152:155], v[96:99], v[48:51], v[152:155]
    v_mfma_f32_16x16x32_bf16 v[156:159], v[96:99], v[36:39], v[156:159]
    v_mfma_f32_16x16x32_bf16 v[152:155], v[100:103], v[52:55], v[152:155]
    v_mfma_f32_16x16x32_bf16 v[156:159], v[100:103], v[36:39], v[156:159]
    v_mfma_f32_16x16x32_bf16 v[152:155], v[104:107], v[56:59], v[152:155]
    v_mfma_f32_16x16x32_bf16 v[156:159], v[104:107], v[36:39], v[156:159]
    s_waitcnt lgkmcnt(13)
    v_mfma_f32_16x16x32_bf16 v[152:155], v[108:111], v[60:63], v[152:155]
    v_mfma_f32_16x16x32_bf16 v[156:159], v[108:111], v[36:39], v[156:159]
    s_waitcnt lgkmcnt(11)
    v_mfma_f32_16x16x32_bf16 v[152:155], v[112:115], v[64:67], v[152:155]
    v_mfma_f32_16x16x32_bf16 v[156:159], v[112:115], v[36:39], v[156:159]
    s_waitcnt lgkmcnt(9)
    v_mfma_f32_16x16x32_bf16 v[152:155], v[116:119], v[68:71], v[152:155]
    v_mfma_f32_16x16x32_bf16 v[156:159], v[116:119], v[36:39], v[156:159]
    s_waitcnt lgkmcnt(7)
    v_mfma_f32_16x16x32_bf16 v[152:155], v[120:123], v[72:75], v[152:155]
    v_mfma_f32_16x16x32_bf16 v[156:159], v[120:123], v[36:39], v[156:159]
    s_waitcnt lgkmcnt(5)
    v_mfma_f32_16x16x32_bf16 v[152:155], v[124:127], v[76:79], v[152:155]
    v_mfma_f32_16x16x32_bf16 v[156:159], v[124:127], v[36:39], v[156:159]
    s_waitcnt lgkmcnt(3)
    v_mfma_f32_16x16x32_bf16 v[152:155], v[128:131], v[80:83], v[152:155]
    v_mfma_f32_16x16x32_bf16 v[156:159], v[128:131], v[36:39], v[156:159]
    s_waitcnt lgkmcnt(1)
    v_mfma_f32_16x16x32_bf16 v[152:155], v[132:135], v[84:87], v[152:155]
    v_mfma_f32_16x16x32_bf16 v[156:159], v[132:135], v[36:39], v[156:159]
    s_nop 7
    v_fma_f32 v152, -v138, v156, v152
    v_mul_f32 v152, v152, v139
    v_fma_f32 v153, -v138, v157, v153
    v_mul_f32 v153, v153, v139
    v_fma_f32 v154, -v138, v158, v154
    v_mul_f32 v154, v154, v139
    v_fma_f32 v155, -v138, v159, v155
    v_mul_f32 v155, v155, v139
    v_cvt_pk_bf16_f32 v140, v152, v153
    v_cvt_pk_bf16_f32 v141, v154, v155
    s_mov_b32 s44, 4096
    buffer_store_dwordx2 v[140:141], v30, s[32:35], s44 offen sc1
    v_xor_b32 v144, v140, v141
    v_mov_b32 v145, v144
    s_nop 1
    v_permlane16_swap_b32 v145, v144
    v_bitop3_b32 v144, v144, v145, s54 bitop3:0x96
    buffer_store_dword v144, v31, s[32:35], s46 offen sc1
    s_branch L_roledone_13
L_notthis_15:
    s_cmp_lg_u32 s63, 2
    s_cbranch_scc1 L_notthis_22
    v_mov_b32 v4, 1
    ds_write_b32 v25, v4 offset:64
    v_lshlrev_b32 v6, 4, v0
    v_lshlrev_b32 v7, 2, v0
    s_sub_u32 s45, s2, 8
    s_lshr_b32 s42, s45, 1
    s_lshl_b32 s42, s42, 10
    s_and_b32 s43, s45, 1
    s_lshl_b32 s43, s43, 9
    s_add_u32 s42, s42, s43
    v_and_b32 v30, 15, v0
    v_lshlrev_b32 v30, 4, v30
    v_lshrrev_b32 v4, 5, v0
    v_lshlrev_b32 v4, 8, v4
    v_add_u32 v30, v30, v4
    v_bfe_u32 v4, v0, 4, 1
    v_lshlrev_b32 v4, 3, v4
    v_add_u32 v30, v30, v4
    v_add_u32 v30, s42, v30
    s_lshr_b32 s42, s45, 1
    s_lshl_b32 s42, s42, 8
    s_and_b32 s43, s45, 1
    s_lshl_b32 s43, s43, 7
    s_add_u32 s43, s43, s42
    s_add_u32 s46, s43, 32768
    v_and_b32 v31, 15, v0
    v_lshlrev_b32 v31, 2, v31
    v_lshrrev_b32 v4, 5, v0
    v_lshlrev_b32 v4, 6, v4
    v_add_u32 v31, v31, v4
    s_waitcnt vmcnt(0)
    s_sleep 80
L_pimg_23:
    s_mov_b32 s44, 4096
    buffer_load_dwordx4 v[88:91], v6, s[32:35], s44 offen offset:0 sc1
    buffer_load_dwordx4 v[92:95], v6, s[32:35], s44 offen offset:1024 sc1
    buffer_load_dwordx4 v[96:99], v6, s[32:35], s44 offen offset:2048 sc1
    buffer_load_dwordx4 v[100:103], v6, s[32:35], s44 offen offset:3072 sc1
    s_add_u32 s44, s44, 4096
    buffer_load_dwordx4 v[104:107], v6, s[32:35], s44 offen offset:0 sc1
    buffer_load_dwordx4 v[108:111], v6, s[32:35], s44 offen offset:1024 sc1
    buffer_load_dwordx4 v[112:115], v6, s[32:35], s44 offen offset:2048 sc1
    buffer_load_dwordx4 v[116:119], v6, s[32:35], s44 offen offset:3072 sc1
    s_add_u32 s44, s44, 4096
    buffer_load_dwordx4 v[120:123], v6, s[32:35], s44 offen offset:0 sc1
    buffer_load_dwordx4 v[124:127], v6, s[32:35], s44 offen offset:1024 sc1
    buffer_load_dwordx4 v[128:131], v6, s[32:35], s44 offen offset:2048 sc1
    buffer_load_dwordx4 v[132:135], v6, s[32:35], s44 offen offset:3072 sc1
    s_mov_b32 s44, 16384
    buffer_load_dword v136, v7, s[32:35], s44 offen offset:0 sc1
    buffer_load_dword v137, v7, s[32:35], s44 offen offset:256 sc1
    buffer_load_dword v138, v7, s[32:35], s44 offen offset:512 sc1
    buffer_load_dword v139, v7, s[32:35], s44 offen offset:768 sc1
    buffer_load_dword v140, v7, s[32:35], s44 offen offset:1024 sc1
    buffer_load_dword v141, v7, s[32:35], s44 offen offset:1280 sc1
    buffer_load_dword v142, v7, s[32:35], s44 offen offset:1536 sc1
    buffer_load_dword v143, v7, s[32:35], s44 offen offset:1792 sc1
    buffer_load_dword v144, v7, s[32:35], s44 offen offset:2048 sc1
    buffer_load_dword v145, v7, s[32:35], s44 offen offset:2304 sc1
    buffer_load_dword v146, v7, s[32:35], s44 offen offset:2560 sc1
    buffer_load_dword v147, v7, s[32:35], s44 offen offset:2816 sc1
    s_waitcnt vmcnt(23)
    v_bitop3_b32 v4, v88, v89, v90 bitop3:0x96
    s_waitcnt vmcnt(11)
    v_bitop3_b32 v4, v4, v91, v136 bitop3:0x96
    v_xor_b32 v5, s54, v4
    v_bitop3_b32 v4, v92, v93, v94 bitop3:0x96
    s_waitcnt vmcnt(10)
    v_bitop3_b32 v4, v4, v95, v137 bitop3:0x96
    v_bitop3_b32 v5, v4, v5, s54 bitop3:0xde
    v_bitop3_b32 v4, v96, v97, v98 bitop3:0x96
    s_waitcnt vmcnt(9)
    v_bitop3_b32 v4, v4, v99, v138 bitop3:0x96
    v_bitop3_b32 v5, v4, v5, s54 bitop3:0xde
    v_bitop3_b32 v4, v100, v101, v102 bitop3:0x96
    s_waitcnt vmcnt(8)
    v_bitop3_b32 v4, v4, v103, v139 bitop3:0x96
    v_bitop3_b32 v5, v4, v5, s54 bitop3:0xde
    v_bitop3_b32 v4, v104, v105, v106 bitop3:0x96
    s_waitcnt vmcnt(7)
    v_bitop3_b32 v4, v4, v107, v140 bitop3:0x96
    v_bitop3_b32 v5, v4, v5, s54 bitop3:0xde
    v_bitop3_b32 v4, v108, v109, v110 bitop3:0x96
    s_waitcnt vmcnt(6)
    v_bitop3_b32 v4, v4, v111, v141 bitop3:0x96
    v_bitop3_b32 v5, v4, v5, s54 bitop3:0xde
    v_bitop3_b32 v4, v112, v113, v114 bitop3:0x96
    s_waitcnt vmcnt(5)
    v_bitop3_b32 v4, v4, v115, v142 bitop3:0x96
    v_bitop3_b32 v5, v4, v5, s54 bitop3:0xde
    v_bitop3_b32 v4, v116, v117, v118 bitop3:0x96
    s_waitcnt vmcnt(4)
    v_bitop3_b32 v4, v4, v119, v143 bitop3:0x96
    v_bitop3_b32 v5, v4, v5, s54 bitop3:0xde
    v_bitop3_b32 v4, v120, v121, v122 bitop3:0x96
    s_waitcnt vmcnt(3)
    v_bitop3_b32 v4, v4, v123, v144 bitop3:0x96
    v_bitop3_b32 v5, v4, v5, s54 bitop3:0xde
    v_bitop3_b32 v4, v124, v125, v126 bitop3:0x96
    s_waitcnt vmcnt(2)
    v_bitop3_b32 v4, v4, v127, v145 bitop3:0x96
    v_bitop3_b32 v5, v4, v5, s54 bitop3:0xde
    v_bitop3_b32 v4, v128, v129, v130 bitop3:0x96
    s_waitcnt vmcnt(1)
    v_bitop3_b32 v4, v4, v131, v146 bitop3:0x96
    v_bitop3_b32 v5, v4, v5, s54 bitop3:0xde
    v_bitop3_b32 v4, v132, v133, v134 bitop3:0x96
    s_waitcnt vmcnt(0)
    v_bitop3_b32 v4, v4, v135, v147 bitop3:0x96
    v_bitop3_b32 v5, v4, v5, s54 bitop3:0xde
    v_cmp_ne_u32 vcc, 0, v5
    s_nop 0
    s_cbranch_vccz L_pimgd_24
    s_sub_u32 s55, s55, 1
    s_cbranch_scc0 L_pimg_23
    s_mov_b32 s55, 0
L_pimgd_24:
    v_mov_b32 v8, 1
    ds_write_b32 v24, v8 offset:308
    v_mfma_f32_16x16x32_bf16 v[152:155], v[40:43], v[88:91], 0
    v_mfma_f32_16x16x32_bf16 v[152:155], v[44:47], v[92:95], v[152:155]
    v_mfma_f32_16x16x32_bf16 v[152:155], v[48:51], v[96:99], v[152:155]
    v_mfma_f32_16x16x32_bf16 v[152:155], v[52:55], v[100:103], v[152:155]
    v_mfma_f32_16x16x32_bf16 v[152:155], v[56:59], v[104:107], v[152:155]
    v_mfma_f32_16x16x32_bf16 v[152:155], v[60:63], v[108:111], v[152:155]
    v_mfma_f32_16x16x32_bf16 v[152:155], v[64:67], v[112:115], v[152:155]
    v_mfma_f32_16x16x32_bf16 v[152:155], v[68:71], v[116:119], v[152:155]
    v_mfma_f32_16x16x32_bf16 v[152:155], v[72:75], v[120:123], v[152:155]
    v_mfma_f32_16x16x32_bf16 v[152:155], v[76:79], v[124:127], v[152:155]
    v_mfma_f32_16x16x32_bf16 v[152:155], v[80:83], v[128:131], v[152:155]
    v_mfma_f32_16x16x32_bf16 v[152:155], v[84:87], v[132:135], v[152:155]
    s_mov_b32 s40, 1033291584
    s_nop 6
    v_mul_f32 v152, s40, v152
    v_mul_f32 v153, s40, v153
    v_mul_f32 v154, s40, v154
    v_mul_f32 v155, s40, v155
    v_cvt_pk_bf16_f32 v140, v152, v153
    v_cvt_pk_bf16_f32 v141, v154, v155
    s_mov_b32 s44, 20480
    buffer_store_dwordx2 v[140:141], v30, s[32:35], s44 offen sc1
    v_xor_b32 v144, v140, v141
    v_mov_b32 v145, v144
    s_nop 1
    v_permlane16_swap_b32 v145, v144
    v_bitop3_b32 v144, v144, v145, s54 bitop3:0x96
    buffer_store_dword v144, v31, s[32:35], s46 offen sc1
    s_branch L_roledone_13
L_notthis_22:
    s_cmp_lg_u32 s63, 3
    s_cbranch_scc1 L_notthis_25
    v_xor_b32 v7, s3, v8
    v_lshlrev_b32 v7, 5, v7
    v_add_u32 v7, v7, v9
    s_waitcnt vmcnt(0)
    v_mov_b32 v4, 1
    ds_write_b32 v25, v4 offset:80
L_spin_26:
    ds_read_b128 v[2:5], v24 offset:80
    s_waitcnt lgkmcnt(0)
    v_min3_u32 v2, v2, v3, v4
    v_min_u32 v2, v2, v5
    s_nop 0
    v_readfirstlane_b32 s61, v2
    s_nop 0
    s_cmp_ge_u32 s61, 1
    s_cbranch_scc0 L_retry_28
L_done_27:
    s_mul_i32 s40, s3, 12288
    s_sub_u32 s40, 147456, s40
    v_add_u32 v144, s40, v10
    v_add_u32 v145, s40, v11
    v_add_u32 v146, s40, v12
    v_add_u32 v147, s40, v13
    ds_read_b128 v[40:43], v144 offset:0
    ds_read_b128 v[44:47], v145 offset:0
    ds_read_b128 v[48:51], v146 offset:0
    ds_read_b128 v[52:55], v147 offset:0
    ds_read_b128 v[56:59], v144 offset:4096
    ds_read_b128 v[60:63], v145 offset:4096
    ds_read_b128 v[64:67], v146 offset:4096
    ds_read_b128 v[68:71], v147 offset:4096
    ds_read_b128 v[72:75], v144 offset:8192
    ds_read_b128 v[76:79], v145 offset:8192
    ds_read_b128 v[80:83], v146 offset:8192
    ds_read_b128 v[84:87], v147 offset:8192
    ds_read_b64_tr_b16 v[88:89], v7 offset:0
    ds_read_b64_tr_b16 v[90:91], v7 offset:512
    ds_read_b64_tr_b16 v[92:93], v7 offset:4096
    ds_read_b64_tr_b16 v[94:95], v7 offset:4608
    ds_read_b64_tr_b16 v[96:97], v7 offset:8192
    ds_read_b64_tr_b16 v[98:99], v7 offset:8704
    ds_read_b64_tr_b16 v[100:101], v7 offset:12288
    ds_read_b64_tr_b16 v[102:103], v7 offset:12800
    ds_read_b64_tr_b16 v[104:105], v7 offset:16384
    ds_read_b64_tr_b16 v[106:107], v7 offset:16896
    ds_read_b64_tr_b16 v[108:109], v7 offset:20480
    ds_read_b64_tr_b16 v[110:111], v7 offset:20992
    ds_read_b64_tr_b16 v[112:113], v7 offset:24576
    ds_read_b64_tr_b16 v[114:115], v7 offset:25088
    ds_read_b64_tr_b16 v[116:117], v7 offset:28672
    ds_read_b64_tr_b16 v[118:119], v7 offset:29184
    ds_read_b64_tr_b16 v[120:121], v7 offset:32768
    ds_read_b64_tr_b16 v[122:123], v7 offset:33280
    ds_read_b64_tr_b16 v[124:125], v7 offset:36864
    ds_read_b64_tr_b16 v[126:127], v7 offset:37376
    ds_read_b64_tr_b16 v[128:129], v7 offset:40960
    ds_read_b64_tr_b16 v[130:131], v7 offset:41472
    ds_read_b64_tr_b16 v[132:133], v7 offset:45056
    ds_read_b64_tr_b16 v[134:135], v7 offset:45568
    v_mov_b32 v4, 1
    ds_write_b32 v25, v4 offset:64
    s_waitcnt lgkmcnt(15)
    v_mfma_f32_16x16x32_bf16 v[152:155], v[40:43], v[88:91], 0
    v_mfma_f32_16x16x32_bf16 v[152:155], v[44:47], v[92:95], v[152:155]
    v_mfma_f32_16x16x32_bf16 v[152:155], v[48:51], v[96:99], v[152:155]
    v_mfma_f32_16x16x32_bf16 v[152:155], v[52:55], v[100:103], v[152:155]
    v_mfma_f32_16x16x32_bf16 v[152:155], v[56:59], v[104:107], v[152:155]
    s_waitcnt lgkmcnt(13)
    v_mfma_f32_16x16x32_bf16 v[152:155], v[60:63], v[108:111], v[152:155]
    s_waitcnt lgkmcnt(11)
    v_mfma_f32_16x16x32_bf16 v[152:155], v[64:67], v[112:115], v[152:155]
    s_waitcnt lgkmcnt(9)
    v_mfma_f32_16x16x32_bf16 v[152:155], v[68:71], v[116:119], v[152:155]
    s_waitcnt lgkmcnt(7)
    v_mfma_f32_16x16x32_bf16 v[152:155], v[72:75], v[120:123], v[152:155]
    s_waitcnt lgkmcnt(5)
    v_mfma_f32_16x16x32_bf16 v[152:155], v[76:79], v[124:127], v[152:155]
    s_waitcnt lgkmcnt(3)
    v_mfma_f32_16x16x32_bf16 v[152:155], v[80:83], v[128:131], v[152:155]
    s_waitcnt lgkmcnt(1)
    v_mfma_f32_16x16x32_bf16 v[152:155], v[84:87], v[132:135], v[152:155]
    s_nop 7
    v_cvt_pk_bf16_f32 v30, v152, v153
    v_cvt_pk_bf16_f32 v31, v154, v155
    s_branch L_roledone_13
L_notthis_25:
L_rolenone_14:
    v_mov_b32 v4, 1
    ds_write_b32 v25, v4 offset:64
L_roledone_13:
L_spin_29:
    ds_read_b32 v2, v24 offset:0
    s_waitcnt lgkmcnt(0)
    v_readfirstlane_b32 s61, v2
    s_nop 0
    s_cmp_ge_u32 s61, 3
    s_cbranch_scc0 L_retry_31
L_done_30:
    ds_read_b128 v[40:43], v10 offset:0
    ds_read_b128 v[44:47], v11 offset:0
    ds_read_b128 v[48:51], v12 offset:0
    ds_read_b128 v[52:55], v13 offset:0
    ds_read_b128 v[56:59], v10 offset:4096
    ds_read_b128 v[60:63], v11 offset:4096
    ds_read_b128 v[64:67], v12 offset:4096
    ds_read_b128 v[68:71], v13 offset:4096
    ds_read_b128 v[72:75], v10 offset:8192
    ds_read_b128 v[76:79], v11 offset:8192
    ds_read_b128 v[80:83], v12 offset:8192
    ds_read_b128 v[84:87], v13 offset:8192
    v_mov_b32 v2, 1
    ds_write_b32 v25, v2 offset:16
    s_waitcnt lgkmcnt(12)
    v_mfma_f32_16x16x32_bf16 v[176:179], v[40:43], v[40:43], 0
    v_mfma_f32_16x16x32_bf16 v[172:175], v[40:43], v[36:39], 0
    s_waitcnt lgkmcnt(11)
    v_mfma_f32_16x16x32_bf16 v[176:179], v[44:47], v[44:47], v[176:179]
    v_mfma_f32_16x16x32_bf16 v[172:175], v[44:47], v[36:39], v[172:175]
    s_waitcnt lgkmcnt(10)
    v_mfma_f32_16x16x32_bf16 v[176:179], v[48:51], v[48:51], v[176:179]
    v_mfma_f32_16x16x32_bf16 v[172:175], v[48:51], v[36:39], v[172:175]
    s_waitcnt lgkmcnt(9)
    v_mfma_f32_16x16x32_bf16 v[176:179], v[52:55], v[52:55], v[176:179]
    v_mfma_f32_16x16x32_bf16 v[172:175], v[52:55], v[36:39], v[172:175]
    s_waitcnt lgkmcnt(8)
    v_mfma_f32_16x16x32_bf16 v[176:179], v[56:59], v[56:59], v[176:179]
    v_mfma_f32_16x16x32_bf16 v[172:175], v[56:59], v[36:39], v[172:175]
    s_waitcnt lgkmcnt(7)
    v_mfma_f32_16x16x32_bf16 v[176:179], v[60:63], v[60:63], v[176:179]
    v_mfma_f32_16x16x32_bf16 v[172:175], v[60:63], v[36:39], v[172:175]
    s_waitcnt lgkmcnt(6)
    v_mfma_f32_16x16x32_bf16 v[176:179], v[64:67], v[64:67], v[176:179]
    v_mfma_f32_16x16x32_bf16 v[172:175], v[64:67], v[36:39], v[172:175]
    s_waitcnt lgkmcnt(5)
    v_mfma_f32_16x16x32_bf16 v[176:179], v[68:71], v[68:71], v[176:179]
    v_mfma_f32_16x16x32_bf16 v[172:175], v[68:71], v[36:39], v[172:175]
    s_waitcnt lgkmcnt(4)
    v_mfma_f32_16x16x32_bf16 v[176:179], v[72:75], v[72:75], v[176:179]
    v_mfma_f32_16x16x32_bf16 v[172:175], v[72:75], v[36:39], v[172:175]
    s_waitcnt lgkmcnt(3)
    v_mfma_f32_16x16x32_bf16 v[176:179], v[76:79], v[76:79], v[176:179]
    v_mfma_f32_16x16x32_bf16 v[172:175], v[76:79], v[36:39], v[172:175]
    s_waitcnt lgkmcnt(2)
    v_mfma_f32_16x16x32_bf16 v[176:179], v[80:83], v[80:83], v[176:179]
    v_mfma_f32_16x16x32_bf16 v[172:175], v[80:83], v[36:39], v[172:175]
    s_waitcnt lgkmcnt(1)
    v_mfma_f32_16x16x32_bf16 v[176:179], v[84:87], v[84:87], v[176:179]
    v_mfma_f32_16x16x32_bf16 v[172:175], v[84:87], v[36:39], v[172:175]
    v_add_u32 v10, 49152, v10
    v_add_u32 v11, 49152, v11
    v_add_u32 v12, 49152, v12
    v_add_u32 v13, 49152, v13
L_spin_32:
    ds_read_b32 v2, v24 offset:0
    s_waitcnt lgkmcnt(0)
    v_readfirstlane_b32 s61, v2
    s_nop 0
    s_cmp_ge_u32 s61, 4
    s_cbranch_scc0 L_retry_34
L_done_33:
    ds_read_b128 v[136:139], v10 offset:0
    ds_read_b128 v[140:143], v11 offset:0
    ds_read_b128 v[144:147], v12 offset:0
    ds_read_b128 v[148:151], v13 offset:0
    s_waitcnt lgkmcnt(3)
    v_mfma_f32_16x16x32_bf16 v[156:159], v[136:139], v[136:139], v[176:179]
    v_mfma_f32_16x16x32_bf16 v[160:163], v[136:139], v[40:43], 0
    v_mfma_f32_16x16x32_bf16 v[164:167], v[136:139], v[36:39], v[172:175]
    ds_read_b32 v2, v24 offset:0
    s_waitcnt lgkmcnt(3)
    v_mfma_f32_16x16x32_bf16 v[156:159], v[140:143], v[140:143], v[156:159]
    v_mfma_f32_16x16x32_bf16 v[160:163], v[140:143], v[44:47], v[160:163]
    v_mfma_f32_16x16x32_bf16 v[164:167], v[140:143], v[36:39], v[164:167]
    s_waitcnt lgkmcnt(0)
    v_readfirstlane_b32 s61, v2
    s_nop 0
    s_cmp_ge_u32 s61, 5
    s_cbranch_scc0 L_notrdy_35
    ds_read_b128 v[204:207], v10 offset:4096
    ds_read_b128 v[208:211], v11 offset:4096
    ds_read_b128 v[212:215], v12 offset:4096
    ds_read_b128 v[216:219], v13 offset:4096
    v_mfma_f32_16x16x32_bf16 v[156:159], v[144:147], v[144:147], v[156:159]
    v_mfma_f32_16x16x32_bf16 v[160:163], v[144:147], v[48:51], v[160:163]
    v_mfma_f32_16x16x32_bf16 v[164:167], v[144:147], v[36:39], v[164:167]
    v_mfma_f32_16x16x32_bf16 v[156:159], v[148:151], v[148:151], v[156:159]
    v_mfma_f32_16x16x32_bf16 v[160:163], v[148:151], v[52:55], v[160:163]
    v_mfma_f32_16x16x32_bf16 v[164:167], v[148:151], v[36:39], v[164:167]
L_next_36:
    s_waitcnt lgkmcnt(3)
    v_mfma_f32_16x16x32_bf16 v[156:159], v[204:207], v[204:207], v[156:159]
    v_mfma_f32_16x16x32_bf16 v[160:163], v[204:207], v[56:59], v[160:163]
    v_mfma_f32_16x16x32_bf16 v[164:167], v[204:207], v[36:39], v[164:167]
    ds_read_b32 v2, v24 offset:0
    s_waitcnt lgkmcnt(3)
    v_mfma_f32_16x16x32_bf16 v[156:159], v[208:211], v[208:211], v[156:159]
    v_mfma_f32_16x16x32_bf16 v[160:163], v[208:211], v[60:63], v[160:163]
    v_mfma_f32_16x16x32_bf16 v[164:167], v[208:211], v[36:39], v[164:167]
    s_waitcnt lgkmcnt(0)
    v_readfirstlane_b32 s61, v2
    s_nop 0
    s_cmp_ge_u32 s61, 6
    s_cbranch_scc0 L_notrdy_37
    ds_read_b128 v[136:139], v10 offset:8192
    ds_read_b128 v[140:143], v11 offset:8192
    ds_read_b128 v[144:147], v12 offset:8192
    ds_read_b128 v[148:151], v13 offset:8192
    v_mfma_f32_16x16x32_bf16 v[156:159], v[212:215], v[212:215], v[156:159]
    v_mfma_f32_16x16x32_bf16 v[160:163], v[212:215], v[64:67], v[160:163]
    v_mfma_f32_16x16x32_bf16 v[164:167], v[212:215], v[36:39], v[164:167]
    v_mfma_f32_16x16x32_bf16 v[156:159], v[216:219], v[216:219], v[156:159]
    v_mfma_f32_16x16x32_bf16 v[160:163], v[216:219], v[68:71], v[160:163]
    v_mfma_f32_16x16x32_bf16 v[164:167], v[216:219], v[36:39], v[164:167]
L_next_38:
    s_waitcnt lgkmcnt(3)
    v_mfma_f32_16x16x32_bf16 v[156:159], v[136:139], v[136:139], v[156:159]
    v_mfma_f32_16x16x32_bf16 v[160:163], v[136:139], v[72:75], v[160:163]
    v_mfma_f32_16x16x32_bf16 v[164:167], v[136:139], v[36:39], v[164:167]
    s_waitcnt lgkmcnt(2)
    v_mfma_f32_16x16x32_bf16 v[156:159], v[140:143], v[140:143], v[156:159]
    v_mfma_f32_16x16x32_bf16 v[160:163], v[140:143], v[76:79], v[160:163]
    v_mfma_f32_16x16x32_bf16 v[164:167], v[140:143], v[36:39], v[164:167]
    s_waitcnt lgkmcnt(1)
    v_mfma_f32_16x16x32_bf16 v[156:159], v[144:147], v[144:147], v[156:159]
    v_mfma_f32_16x16x32_bf16 v[160:163], v[144:147], v[80:83], v[160:163]
    v_mfma_f32_16x16x32_bf16 v[164:167], v[144:147], v[36:39], v[164:167]
    s_waitcnt lgkmcnt(0)
    v_mfma_f32_16x16x32_bf16 v[156:159], v[148:151], v[148:151], v[156:159]
    v_mfma_f32_16x16x32_bf16 v[160:163], v[148:151], v[84:87], v[160:163]
    v_mfma_f32_16x16x32_bf16 v[164:167], v[148:151], v[36:39], v[164:167]
    s_nop 6
    v_pk_fma_f32 v[156:157], v[160:161], s[96:97], v[156:157]
    v_pk_fma_f32 v[158:159], v[162:163], s[96:97], v[158:159]
    v_cndmask_b32 v2, v156, v157, s[4:5]
    v_cndmask_b32 v2, v2, v158, s[6:7]
    v_cndmask_b32 v2, v2, v159, s[8:9]
    v_pk_mul_f32 v[180:181], v[164:165], s[52:53]
    v_pk_mul_f32 v[182:183], v[166:167], s[52:53]
    v_mov_b32 v3, v2
    s_nop 1
    v_mov_b32_dpp v3, v2 row_ror:12 row_mask:0x2 bank_mask:0xf
    s_nop 1
    v_mov_b32_dpp v3, v2 row_ror:8 row_mask:0x4 bank_mask:0xf
    s_nop 1
    v_mov_b32_dpp v3, v2 row_ror:4 row_mask:0x8 bank_mask:0xf
    v_pk_mul_f32 v[164:165], v[180:181], v[180:181]
    v_pk_mul_f32 v[166:167], v[182:183], v[182:183]
    v_mov_b32_dpp v184, v3 row_newbcast:0 row_mask:0xf bank_mask:0xf
    v_mov_b32_dpp v185, v3 row_newbcast:1 row_mask:0xf bank_mask:0xf
    v_mov_b32_dpp v186, v3 row_newbcast:2 row_mask:0xf bank_mask:0xf
    v_mov_b32_dpp v187, v3 row_newbcast:3 row_mask:0xf bank_mask:0xf
    v_pk_fma_f32 v[184:185], v[184:185], s[52:53], v[164:165] neg_lo:[0,0,1] neg_hi:[0,0,1]
    v_pk_fma_f32 v[186:187], v[186:187], s[52:53], v[166:167] neg_lo:[0,0,1] neg_hi:[0,0,1]
    v_add_f32 v184, s98, abs(v184)
    v_add_f32 v185, s98, abs(v185)
    v_add_f32 v186, s98, abs(v186)
    v_add_f32 v187, s98, abs(v187)
    v_rsq_f32 v184, v184
    v_rsq_f32 v185, v185
    v_rsq_f32 v186, v186
    v_rsq_f32 v187, v187
    s_cmp_lg_u32 s63, 3
    s_cbranch_scc1 L_nowvostore_39
    s_sub_u32 s41, s2, 32
    s_mul_i32 s40, s41, 10923
    s_lshr_b32 s40, s40, 16
    s_mul_i32 s42, s40, 6
    s_sub_u32 s41, s41, s42
    s_lshl_b32 s41, s41, 2
    s_add_u32 s41, s41, s3
    s_mul_i32 s41, s41, 24
    s_add_u32 s41, s41, s40
    s_lshl_b32 s41, s41, 9
    s_add_u32 s41, s41, 65536
    v_lshlrev_b32 v6, 3, v0
    buffer_store_dwordx2 v[30:31], v6, s[32:35], s41 offen sc1
L_nowvostore_39:
    v_add_u32 v10, 49152, v10
    v_add_u32 v11, 49152, v11
    v_add_u32 v12, 49152, v12
    v_add_u32 v13, 49152, v13
L_spin_40:
    ds_read_b32 v2, v24 offset:0
    s_waitcnt lgkmcnt(0)
    v_readfirstlane_b32 s61, v2
    s_nop 0
    s_cmp_ge_u32 s61, 7
    s_cbranch_scc0 L_retry_42
L_done_41:
    ds_read_b128 v[136:139], v10 offset:0
    ds_read_b128 v[140:143], v11 offset:0
    ds_read_b128 v[144:147], v12 offset:0
    ds_read_b128 v[148:151], v13 offset:0
    s_waitcnt lgkmcnt(3)
    v_mfma_f32_16x16x32_bf16 v[156:159], v[136:139], v[136:139], v[176:179]
    v_mfma_f32_16x16x32_bf16 v[160:163], v[136:139], v[40:43], 0
    v_mfma_f32_16x16x32_bf16 v[164:167], v[136:139], v[36:39], v[172:175]
    ds_read_b32 v2, v24 offset:0
    s_waitcnt lgkmcnt(3)
    v_mfma_f32_16x16x32_bf16 v[156:159], v[140:143], v[140:143], v[156:159]
    v_mfma_f32_16x16x32_bf16 v[160:163], v[140:143], v[44:47], v[160:163]
    v_mfma_f32_16x16x32_bf16 v[164:167], v[140:143], v[36:39], v[164:167]
    s_waitcnt lgkmcnt(0)
    v_readfirstlane_b32 s61, v2
    s_nop 0
    s_cmp_ge_u32 s61, 8
    s_cbranch_scc0 L_notrdy_43
    ds_read_b128 v[204:207], v10 offset:4096
    ds_read_b128 v[208:211], v11 offset:4096
    ds_read_b128 v[212:215], v12 offset:4096
    ds_read_b128 v[216:219], v13 offset:4096
    v_mfma_f32_16x16x32_bf16 v[156:159], v[144:147], v[144:147], v[156:159]
    v_mfma_f32_16x16x32_bf16 v[160:163], v[144:147], v[48:51], v[160:163]
    v_mfma_f32_16x16x32_bf16 v[164:167], v[144:147], v[36:39], v[164:167]
    v_mfma_f32_16x16x32_bf16 v[156:159], v[148:151], v[148:151], v[156:159]
    v_mfma_f32_16x16x32_bf16 v[160:163], v[148:151], v[52:55], v[160:163]
    v_mfma_f32_16x16x32_bf16 v[164:167], v[148:151], v[36:39], v[164:167]
L_next_44:
    s_waitcnt lgkmcnt(3)
    v_mfma_f32_16x16x32_bf16 v[156:159], v[204:207], v[204:207], v[156:159]
    v_mfma_f32_16x16x32_bf16 v[160:163], v[204:207], v[56:59], v[160:163]
    v_mfma_f32_16x16x32_bf16 v[164:167], v[204:207], v[36:39], v[164:167]
    ds_read_b32 v2, v24 offset:0
    s_waitcnt lgkmcnt(3)
    v_mfma_f32_16x16x32_bf16 v[156:159], v[208:211], v[208:211], v[156:159]
    v_mfma_f32_16x16x32_bf16 v[160:163], v[208:211], v[60:63], v[160:163]
    v_mfma_f32_16x16x32_bf16 v[164:167], v[208:211], v[36:39], v[164:167]
    s_waitcnt lgkmcnt(0)
    v_readfirstlane_b32 s61, v2
    s_nop 0
    s_cmp_ge_u32 s61, 9
    s_cbranch_scc0 L_notrdy_45
    ds_read_b128 v[136:139], v10 offset:8192
    ds_read_b128 v[140:143], v11 offset:8192
    ds_read_b128 v[144:147], v12 offset:8192
    ds_read_b128 v[148:151], v13 offset:8192
    v_mfma_f32_16x16x32_bf16 v[156:159], v[212:215], v[212:215], v[156:159]
    v_mfma_f32_16x16x32_bf16 v[160:163], v[212:215], v[64:67], v[160:163]
    v_mfma_f32_16x16x32_bf16 v[164:167], v[212:215], v[36:39], v[164:167]
    v_mfma_f32_16x16x32_bf16 v[156:159], v[216:219], v[216:219], v[156:159]
    v_mfma_f32_16x16x32_bf16 v[160:163], v[216:219], v[68:71], v[160:163]
    v_mfma_f32_16x16x32_bf16 v[164:167], v[216:219], v[36:39], v[164:167]
L_next_46:
    s_waitcnt lgkmcnt(3)
    v_mfma_f32_16x16x32_bf16 v[156:159], v[136:139], v[136:139], v[156:159]
    v_mfma_f32_16x16x32_bf16 v[160:163], v[136:139], v[72:75], v[160:163]
    v_mfma_f32_16x16x32_bf16 v[164:167], v[136:139], v[36:39], v[164:167]
    s_waitcnt lgkmcnt(2)
    v_mfma_f32_16x16x32_bf16 v[156:159], v[140:143], v[140:143], v[156:159]
    v_mfma_f32_16x16x32_bf16 v[160:163], v[140:143], v[76:79], v[160:163]
    v_mfma_f32_16x16x32_bf16 v[164:167], v[140:143], v[36:39], v[164:167]
    s_waitcnt lgkmcnt(1)
    v_mfma_f32_16x16x32_bf16 v[156:159], v[144:147], v[144:147], v[156:159]
    v_mfma_f32_16x16x32_bf16 v[160:163], v[144:147], v[80:83], v[160:163]
    v_mfma_f32_16x16x32_bf16 v[164:167], v[144:147], v[36:39], v[164:167]
    s_waitcnt lgkmcnt(0)
    v_mfma_f32_16x16x32_bf16 v[156:159], v[148:151], v[148:151], v[156:159]
    v_mfma_f32_16x16x32_bf16 v[160:163], v[148:151], v[84:87], v[160:163]
    v_mfma_f32_16x16x32_bf16 v[164:167], v[148:151], v[36:39], v[164:167]
    s_nop 6
    v_pk_fma_f32 v[156:157], v[160:161], s[96:97], v[156:157]
    v_pk_fma_f32 v[158:159], v[162:163], s[96:97], v[158:159]
    v_cndmask_b32 v2, v156, v157, s[4:5]
    v_cndmask_b32 v2, v2, v158, s[6:7]
    v_cndmask_b32 v2, v2, v159, s[8:9]
    v_pk_mul_f32 v[188:189], v[164:165], s[52:53]
    v_pk_mul_f32 v[190:191], v[166:167], s[52:53]
    v_mov_b32 v3, v2
    s_nop 1
    v_mov_b32_dpp v3, v2 row_ror:12 row_mask:0x2 bank_mask:0xf
    s_nop 1
    v_mov_b32_dpp v3, v2 row_ror:8 row_mask:0x4 bank_mask:0xf
    s_nop 1
    v_mov_b32_dpp v3, v2 row_ror:4 row_mask:0x8 bank_mask:0xf
    v_pk_mul_f32 v[164:165], v[188:189], v[188:189]
    v_pk_mul_f32 v[166:167], v[190:191], v[190:191]
    v_mov_b32_dpp v192, v3 row_newbcast:0 row_mask:0xf bank_mask:0xf
    v_mov_b32_dpp v193, v3 row_newbcast:1 row_mask:0xf bank_mask:0xf
    v_mov_b32_dpp v194, v3 row_newbcast:2 row_mask:0xf bank_mask:0xf
    v_mov_b32_dpp v195, v3 row_newbcast:3 row_mask:0xf bank_mask:0xf
    v_pk_fma_f32 v[192:193], v[192:193], s[52:53], v[164:165] neg_lo:[0,0,1] neg_hi:[0,0,1]
    v_pk_fma_f32 v[194:195], v[194:195], s[52:53], v[166:167] neg_lo:[0,0,1] neg_hi:[0,0,1]
    v_add_f32 v192, s98, abs(v192)
    v_add_f32 v193, s98, abs(v193)
    v_add_f32 v194, s98, abs(v194)
    v_add_f32 v195, s98, abs(v195)
    v_rsq_f32 v192, v192
    v_rsq_f32 v193, v193
    v_rsq_f32 v194, v194
    v_rsq_f32 v195, v195
    s_cmp_lg_u32 s63, 3
    s_cbranch_scc1 L_nowvoflag_47
    s_waitcnt vmcnt(0)
    s_sub_u32 s41, s2, 32
    s_mul_i32 s40, s41, 10923
    s_lshr_b32 s40, s40, 16
    s_mul_i32 s42, s40, 6
    s_sub_u32 s41, s41, s42
    s_lshl_b32 s41, s41, 2
    s_add_u32 s41, s41, s3
    s_lshl_b32 s40, s40, 2
    s_lshl_b32 s41, s41, 7
    s_add_u32 s40, s40, s41
    s_add_u32 s40, s40, 458752
    v_mov_b32 v4, s54
    v_mov_b32 v5, 0
    s_mov_b64 exec, 1
    buffer_store_dword v4, v5, s[32:35], s40 offen sc1
    s_mov_b64 exec, -1
L_nowvoflag_47:
    v_lshlrev_b32 v6, 4, v0
    v_add_u32 v6, 147456, v6
    v_add_u32 v2, 4294918144, v10
    v_add_u32 v3, 4294918144, v11
    v_add_u32 v4, 4294918144, v12
    v_add_u32 v5, 4294918144, v13
    ds_read_b128 v[136:139], v2 offset:0
    ds_read_b128 v[204:207], v10 offset:0
    ds_read_b128 v[140:143], v3 offset:0
    ds_read_b128 v[208:211], v11 offset:0
    ds_read_b128 v[144:147], v4 offset:0
    ds_read_b128 v[212:215], v12 offset:0
    ds_read_b128 v[148:151], v5 offset:0
    ds_read_b128 v[216:219], v13 offset:0
    s_waitcnt lgkmcnt(0)
L_spin_48:
    ds_read_b32 v8, v24 offset:4
    s_waitcnt lgkmcnt(0)
    v_readfirstlane_b32 s61, v8
    s_nop 0
    s_cmp_ge_u32 s61, 1
    s_cbranch_scc0 L_retry_50
L_done_49:
    v_and_b32 v7, 15, v0
    v_lshlrev_b32 v7, 2, v7
    v_add_u32 v7, 160064, v7
    ds_read_b128 v[88:91], v6 offset:0
    ds_read_b128 v[92:95], v6 offset:1024
    ds_read_b128 v[96:99], v6 offset:2048
    ds_read_b128 v[100:103], v6 offset:3072
    ds_read_b128 v[104:107], v6 offset:4096
    ds_read_b128 v[108:111], v6 offset:5120
    ds_read_b128 v[112:115], v6 offset:6144
    ds_read_b128 v[116:119], v6 offset:7168
    ds_read_b128 v[120:123], v6 offset:8192
    ds_read_b128 v[124:127], v6 offset:9216
    ds_read_b128 v[128:131], v6 offset:10240
    ds_read_b128 v[132:135], v6 offset:11264
    ds_read_b32 v26, v7
    v_add_u32 v14, 49152, v14
    v_add_u32 v15, 49152, v15
    v_add_u32 v16, 49152, v16
    v_add_u32 v17, 49152, v17
    v_add_u32 v18, 49152, v18
    v_add_u32 v19, 49152, v19
    s_waitcnt lgkmcnt(12)
    v_mfma_f32_16x16x32_bf16 v[168:171], v[40:43], v[88:91], 0
    v_mfma_f32_16x16x32_bf16 v[152:155], v[136:139], v[88:91], 0
    v_mfma_f32_16x16x32_bf16 v[156:159], v[204:207], v[88:91], 0
    ds_read_b128 v[136:139], v2 offset:4096
    ds_read_b128 v[204:207], v10 offset:4096
    s_waitcnt lgkmcnt(13)
    v_mfma_f32_16x16x32_bf16 v[168:171], v[44:47], v[92:95], v[168:171]
    v_mfma_f32_16x16x32_bf16 v[152:155], v[140:143], v[92:95], v[152:155]
    v_mfma_f32_16x16x32_bf16 v[156:159], v[208:211], v[92:95], v[156:159]
    ds_read_b128 v[140:143], v3 offset:4096
    ds_read_b128 v[208:211], v11 offset:4096
    s_waitcnt lgkmcnt(14)
    v_mfma_f32_16x16x32_bf16 v[168:171], v[48:51], v[96:99], v[168:171]
    v_mfma_f32_16x16x32_bf16 v[152:155], v[144:147], v[96:99], v[152:155]
    v_mfma_f32_16x16x32_bf16 v[156:159], v[212:215], v[96:99], v[156:159]
    ds_read_b128 v[144:147], v4 offset:4096
    ds_read_b128 v[212:215], v12 offset:4096
    s_waitcnt lgkmcnt(15)
    v_mfma_f32_16x16x32_bf16 v[168:171], v[52:55], v[100:103], v[168:171]
    v_mfma_f32_16x16x32_bf16 v[152:155], v[148:151], v[100:103], v[152:155]
    v_mfma_f32_16x16x32_bf16 v[156:159], v[216:219], v[100:103], v[156:159]
    ds_read_b128 v[148:151], v5 offset:4096
    ds_read_b128 v[216:219], v13 offset:4096
    s_waitcnt lgkmcnt(15)
    v_mfma_f32_16x16x32_bf16 v[168:171], v[56:59], v[104:107], v[168:171]
    s_waitcnt lgkmcnt(7)
    v_mfma_f32_16x16x32_bf16 v[152:155], v[136:139], v[104:107], v[152:155]
    s_waitcnt lgkmcnt(6)
    v_mfma_f32_16x16x32_bf16 v[156:159], v[204:207], v[104:107], v[156:159]
    ds_read_b128 v[136:139], v2 offset:8192
    ds_read_b128 v[204:207], v10 offset:8192
    v_mfma_f32_16x16x32_bf16 v[168:171], v[60:63], v[108:111], v[168:171]
    s_waitcnt lgkmcnt(7)
    v_mfma_f32_16x16x32_bf16 v[152:155], v[140:143], v[108:111], v[152:155]
    s_waitcnt lgkmcnt(6)
    v_mfma_f32_16x16x32_bf16 v[156:159], v[208:211], v[108:111], v[156:159]
    ds_read_b128 v[140:143], v3 offset:8192
    ds_read_b128 v[208:211], v11 offset:8192
    v_mfma_f32_16x16x32_bf16 v[168:171], v[64:67], v[112:115], v[168:171]
    s_waitcnt lgkmcnt(7)
    v_mfma_f32_16x16x32_bf16 v[152:155], v[144:147], v[112:115], v[152:155]
    s_waitcnt lgkmcnt(6)
    v_mfma_f32_16x16x32_bf16 v[156:159], v[212:215], v[112:115], v[156:159]
    ds_read_b128 v[144:147], v4 offset:8192
    ds_read_b128 v[212:215], v12 offset:8192
    v_mfma_f32_16x16x32_bf16 v[168:171], v[68:71], v[116:119], v[168:171]
    s_waitcnt lgkmcnt(7)
    v_mfma_f32_16x16x32_bf16 v[152:155], v[148:151], v[116:119], v[152:155]
    s_waitcnt lgkmcnt(6)
    v_mfma_f32_16x16x32_bf16 v[156:159], v[216:219], v[116:119], v[156:159]
    ds_read_b128 v[148:151], v5 offset:8192
    ds_read_b128 v[216:219], v13 offset:8192
    v_mfma_f32_16x16x32_bf16 v[168:171], v[72:75], v[120:123], v[168:171]
    s_waitcnt lgkmcnt(7)
    v_mfma_f32_16x16x32_bf16 v[152:155], v[136:139], v[120:123], v[152:155]
    s_waitcnt lgkmcnt(6)
    v_mfma_f32_16x16x32_bf16 v[156:159], v[204:207], v[120:123], v[156:159]
    v_mfma_f32_16x16x32_bf16 v[168:171], v[76:79], v[124:127], v[168:171]
    s_waitcnt lgkmcnt(5)
    v_mfma_f32_16x16x32_bf16 v[152:155], v[140:143], v[124:127], v[152:155]
    s_waitcnt lgkmcnt(4)
    v_mfma_f32_16x16x32_bf16 v[156:159], v[208:211], v[124:127], v[156:159]
    v_mfma_f32_16x16x32_bf16 v[168:171], v[80:83], v[128:131], v[168:171]
    s_waitcnt lgkmcnt(3)
    v_mfma_f32_16x16x32_bf16 v[152:155], v[144:147], v[128:131], v[152:155]
    s_waitcnt lgkmcnt(2)
    v_mfma_f32_16x16x32_bf16 v[156:159], v[212:215], v[128:131], v[156:159]
    v_mfma_f32_16x16x32_bf16 v[168:171], v[84:87], v[132:135], v[168:171]
    s_waitcnt lgkmcnt(1)
    v_mfma_f32_16x16x32_bf16 v[152:155], v[148:151], v[132:135], v[152:155]
    s_waitcnt lgkmcnt(0)
    v_mfma_f32_16x16x32_bf16 v[156:159], v[216:219], v[132:135], v[156:159]
    ds_read_b64_tr_b16 v[236:237], v14 offset:0
    ds_read_b64_tr_b16 v[238:239], v14 offset:12288
    ds_read_b64_tr_b16 v[240:241], v14 offset:24576
    ds_read_b64_tr_b16 v[242:243], v14 offset:36864
    ds_read_b64_tr_b16 v[244:245], v15 offset:0
    ds_read_b64_tr_b16 v[246:247], v15 offset:12288
    ds_read_b64_tr_b16 v[248:249], v15 offset:24576
    ds_read_b64_tr_b16 v[250:251], v15 offset:36864
    ds_read_b64_tr_b16 v[252:253], v16 offset:0
    ds_read_b64_tr_b16 v[254:255], v16 offset:12288
    ds_read_b64_tr_b16 v[204:205], v16 offset:24576
    ds_read_b64_tr_b16 v[206:207], v16 offset:36864
    v_pk_add_f32 v[152:153], v[152:153], v[168:169]
    v_pk_add_f32 v[154:155], v[154:155], v[170:171]
    v_pk_add_f32 v[156:157], v[156:157], v[168:169]
    v_pk_add_f32 v[158:159], v[158:159], v[170:171]
    v_pk_fma_f32 v[152:153], v[180:181], v[26:27], v[152:153] op_sel_hi:[1,0,1] neg_lo:[1,0,0] neg_hi:[1,0,0]
    v_pk_fma_f32 v[154:155], v[182:183], v[26:27], v[154:155] op_sel_hi:[1,0,1] neg_lo:[1,0,0] neg_hi:[1,0,0]
    v_pk_mul_f32 v[152:153], v[152:153], v[184:185]
    v_pk_mul_f32 v[154:155], v[154:155], v[186:187]
    v_pk_fma_f32 v[156:157], v[188:189], v[26:27], v[156:157] op_sel_hi:[1,0,1] neg_lo:[1,0,0] neg_hi:[1,0,0]
    v_pk_fma_f32 v[158:159], v[190:191], v[26:27], v[158:159] op_sel_hi:[1,0,1] neg_lo:[1,0,0] neg_hi:[1,0,0]
    v_pk_mul_f32 v[156:157], v[156:157], v[192:193]
    v_pk_mul_f32 v[158:159], v[158:159], v[194:195]
    v_max3_f32 v2, v152, v153, v154
    v_max3_f32 v2, v2, v155, v156
    v_max3_f32 v2, v2, v157, v158
    v_max_f32 v2, v2, v159
    v_mov_b32 v3, v2
    s_nop 1
    v_permlane32_swap_b32 v3, v2
    v_max_f32 v2, v2, v3
    v_mov_b32 v3, v2
    s_nop 1
    v_permlane16_swap_b32 v3, v2
    v_max_f32 v2, v2, v3
    ds_write_b32 v22, v2
    v_mov_b32 v3, 1
    ds_write_b32 v25, v3 offset:112
    ds_read_b64_tr_b16 v[208:209], v17 offset:0
    ds_read_b64_tr_b16 v[210:211], v17 offset:12288
    ds_read_b64_tr_b16 v[212:213], v17 offset:24576
    ds_read_b64_tr_b16 v[214:215], v17 offset:36864
    ds_read_b64_tr_b16 v[216:217], v18 offset:0
    ds_read_b64_tr_b16 v[218:219], v18 offset:12288
    ds_read_b64_tr_b16 v[136:137], v18 offset:24576
    ds_read_b64_tr_b16 v[138:139], v18 offset:36864
    ds_read_b64_tr_b16 v[140:141], v19 offset:0
    ds_read_b64_tr_b16 v[142:143], v19 offset:12288
    ds_read_b64_tr_b16 v[144:145], v19 offset:24576
    ds_read_b64_tr_b16 v[146:147], v19 offset:36864
    v_mov_b32 v6, 1
    ds_write_b32 v25, v6 offset:32
L_mx_51:
    ds_read_b128 v[2:5], v24 offset:112
    ds_read_b128 v[220:223], v23
    s_waitcnt lgkmcnt(1)
    v_min3_u32 v2, v2, v3, v4
    v_min_u32 v2, v2, v5
    s_nop 0
    v_readfirstlane_b32 s61, v2
    s_nop 0
    s_cmp_ge_u32 s61, 1
    s_cbranch_scc1 L_mxd_52
    s_sub_u32 s62, s62, 1
    s_cbranch_scc0 L_mx_51
    s_mov_b32 s62, 0
L_mxd_52:
    s_waitcnt lgkmcnt(0)
    v_max3_f32 v2, v220, v221, v222
    v_max_f32 v2, v2, v223
    v_and_b32 v3, 0xffff0000, v2
    v_cmp_gt_f32 vcc, v2, v3
    v_add_u32 v4, 0x10000, v3
    s_nop 0
    v_cndmask_b32 v28, v3, v4, vcc
    v_pk_add_f32 v[152:153], v[152:153], v[28:29] op_sel_hi:[1,0] neg_lo:[0,1] neg_hi:[0,1]
    v_pk_add_f32 v[154:155], v[154:155], v[28:29] op_sel_hi:[1,0] neg_lo:[0,1] neg_hi:[0,1]
    v_pk_add_f32 v[156:157], v[156:157], v[28:29] op_sel_hi:[1,0] neg_lo:[0,1] neg_hi:[0,1]
    v_pk_add_f32 v[158:159], v[158:159], v[28:29] op_sel_hi:[1,0] neg_lo:[0,1] neg_hi:[0,1]
    v_exp_f32 v152, v152
    v_exp_f32 v153, v153
    v_exp_f32 v154, v154
    v_exp_f32 v155, v155
    v_exp_f32 v156, v156
    v_exp_f32 v157, v157
    v_exp_f32 v158, v158
    v_exp_f32 v159, v159
    v_pk_mul_f32 v[160:161], v[152:153], v[184:185]
    v_pk_mul_f32 v[162:163], v[154:155], v[186:187]
    v_pk_mul_f32 v[164:165], v[156:157], v[192:193]
    v_pk_mul_f32 v[166:167], v[158:159], v[194:195]
    v_cvt_pk_bf16_f32 v30, v160, v161
    v_cvt_pk_bf16_f32 v31, v162, v163
    v_cvt_pk_bf16_f32 v8, v164, v165
    v_cvt_pk_bf16_f32 v9, v166, v167
    ds_write_b64 v20, v[30:31]
    ds_write_b64 v20, v[8:9] offset:2048
    v_mov_b32 v2, 1
    ds_write_b32 v25, v2 offset:144
    v_pk_add_f32 v[32:33], v[160:161], v[164:165]
    v_pk_add_f32 v[34:35], v[162:163], v[166:167]
    v_pk_add_f32 v[152:153], v[152:153], v[156:157]
    v_pk_add_f32 v[154:155], v[154:155], v[158:159]
    v_add_f32 v152, v152, v153
    v_add_f32 v154, v154, v155
    v_add_f32 v29, v152, v154
L_xsp_53:
    ds_read_b128 v[2:5], v24 offset:144
    ds_read2st64_b64 v[220:223], v21 offset0:0 offset1:1
    ds_read2st64_b64 v[224:227], v21 offset0:2 offset1:3
    ds_read2st64_b64 v[228:231], v21 offset0:4 offset1:5
    ds_read2st64_b64 v[232:235], v21 offset0:6 offset1:7
    s_waitcnt lgkmcnt(4)
    v_min3_u32 v7, v2, v3, v4
    v_min_u32 v7, v7, v5
    s_nop 0
    v_readfirstlane_b32 s61, v7
    s_nop 0
    s_cmp_ge_u32 s61, 1
    s_cbranch_scc0 L_xretry_55
L_xok_54:
    s_waitcnt lgkmcnt(0)
    v_add_u32 v2, 49152, v14
    v_add_u32 v3, 49152, v15
    v_add_u32 v4, 49152, v16
    v_add_u32 v5, 49152, v17
    v_add_u32 v6, 49152, v18
    v_add_u32 v7, 49152, v19
    v_mfma_f32_16x16x32_bf16 v[180:183], v[236:239], v[220:223], 0
    ds_read_b64_tr_b16 v[236:237], v2 offset:0
    ds_read_b64_tr_b16 v[238:239], v2 offset:12288
    v_mfma_f32_16x16x32_bf16 v[180:183], v[240:243], v[224:227], v[180:183]
    ds_read_b64_tr_b16 v[240:241], v2 offset:24576
    ds_read_b64_tr_b16 v[242:243], v2 offset:36864
    v_mfma_f32_16x16x32_bf16 v[184:187], v[244:247], v[220:223], 0
    ds_read_b64_tr_b16 v[244:245], v3 offset:0
    ds_read_b64_tr_b16 v[246:247], v3 offset:12288
    v_mfma_f32_16x16x32_bf16 v[184:187], v[248:251], v[224:227], v[184:187]
    ds_read_b64_tr_b16 v[248:249], v3 offset:24576
    ds_read_b64_tr_b16 v[250:251], v3 offset:36864
    v_mfma_f32_16x16x32_bf16 v[188:191], v[252:255], v[220:223], 0
    ds_read_b64_tr_b16 v[252:253], v4 offset:0
    ds_read_b64_tr_b16 v[254:255], v4 offset:12288
    v_mfma_f32_16x16x32_bf16 v[188:191], v[204:207], v[224:227], v[188:191]
    ds_read_b64_tr_b16 v[204:205], v4 offset:24576
    ds_read_b64_tr_b16 v[206:207], v4 offset:36864
    v_mfma_f32_16x16x32_bf16 v[192:195], v[208:211], v[220:223], 0
    ds_read_b64_tr_b16 v[208:209], v5 offset:0
    ds_read_b64_tr_b16 v[210:211], v5 offset:12288
    v_mfma_f32_16x16x32_bf16 v[192:195], v[212:215], v[224:227], v[192:195]
    ds_read_b64_tr_b16 v[212:213], v5 offset:24576
    ds_read_b64_tr_b16 v[214:215], v5 offset:36864
    v_mfma_f32_16x16x32_bf16 v[196:199], v[216:219], v[220:223], 0
    ds_read_b64_tr_b16 v[216:217], v6 offset:0
    ds_read_b64_tr_b16 v[218:219], v6 offset:12288
    v_mfma_f32_16x16x32_bf16 v[196:199], v[136:139], v[224:227], v[196:199]
    ds_read_b64_tr_b16 v[136:137], v6 offset:24576
    ds_read_b64_tr_b16 v[138:139], v6 offset:36864
    v_mfma_f32_16x16x32_bf16 v[200:203], v[140:143], v[220:223], 0
    ds_read_b64_tr_b16 v[140:141], v7 offset:0
    ds_read_b64_tr_b16 v[142:143], v7 offset:12288
    v_mfma_f32_16x16x32_bf16 v[200:203], v[144:147], v[224:227], v[200:203]
    ds_read_b64_tr_b16 v[144:145], v7 offset:24576
    ds_read_b64_tr_b16 v[146:147], v7 offset:36864
    s_waitcnt lgkmcnt(15)
    v_mfma_f32_16x16x32_bf16 v[180:183], v[236:239], v[228:231], v[180:183]
    v_mfma_f32_16x16x32_bf16 v[180:183], v[240:243], v[232:235], v[180:183]
    v_mfma_f32_16x16x32_bf16 v[184:187], v[244:247], v[228:231], v[184:187]
    v_mfma_f32_16x16x32_bf16 v[184:187], v[248:251], v[232:235], v[184:187]
    s_waitcnt lgkmcnt(14)
    v_mfma_f32_16x16x32_bf16 v[188:191], v[252:255], v[228:231], v[188:191]
    s_waitcnt lgkmcnt(12)
    v_mfma_f32_16x16x32_bf16 v[188:191], v[204:207], v[232:235], v[188:191]
    s_waitcnt lgkmcnt(10)
    v_mfma_f32_16x16x32_bf16 v[192:195], v[208:211], v[228:231], v[192:195]
    s_waitcnt lgkmcnt(8)
    v_mfma_f32_16x16x32_bf16 v[192:195], v[212:215], v[232:235], v[192:195]
    s_waitcnt lgkmcnt(6)
    v_mfma_f32_16x16x32_bf16 v[196:199], v[216:219], v[228:231], v[196:199]
    s_waitcnt lgkmcnt(4)
    v_mfma_f32_16x16x32_bf16 v[196:199], v[136:139], v[232:235], v[196:199]
    s_waitcnt lgkmcnt(2)
    v_mfma_f32_16x16x32_bf16 v[200:203], v[140:143], v[228:231], v[200:203]
    s_waitcnt lgkmcnt(0)
    v_mfma_f32_16x16x32_bf16 v[200:203], v[144:147], v[232:235], v[200:203]
    v_mov_b32 v8, 1
    ds_write_b32 v25, v8 offset:256
    v_add_u32 v10, 4294918144, v10
    v_add_u32 v11, 4294918144, v11
    v_add_u32 v12, 4294918144, v12
    v_add_u32 v13, 4294918144, v13
L_spin_56:
    ds_read_b64 v[2:3], v24 offset:240
    s_waitcnt lgkmcnt(0)
    v_min_u32 v2, v2, v3
    s_nop 0
    v_readfirstlane_b32 s61, v2
    s_nop 0
    s_cmp_ge_u32 s61, 1
    s_cbranch_scc0 L_retry_58
L_done_57:
    ds_read_b128 v[136:139], v10 offset:0
    ds_read_b128 v[140:143], v11 offset:0
    ds_read_b128 v[144:147], v12 offset:0
    ds_read_b128 v[148:151], v13 offset:0
    s_waitcnt lgkmcnt(3)
    v_mfma_f32_16x16x32_bf16 v[156:159], v[136:139], v[136:139], v[176:179]
    v_mfma_f32_16x16x32_bf16 v[160:163], v[136:139], v[40:43], 0
    v_mfma_f32_16x16x32_bf16 v[164:167], v[136:139], v[36:39], v[172:175]
    v_mfma_f32_16x16x32_bf16 v[152:155], v[136:139], v[88:91], v[168:171]
    ds_read_b64 v[2:3], v24 offset:240
    s_waitcnt lgkmcnt(3)
    v_mfma_f32_16x16x32_bf16 v[156:159], v[140:143], v[140:143], v[156:159]
    v_mfma_f32_16x16x32_bf16 v[160:163], v[140:143], v[44:47], v[160:163]
    v_mfma_f32_16x16x32_bf16 v[164:167], v[140:143], v[36:39], v[164:167]
    v_mfma_f32_16x16x32_bf16 v[152:155], v[140:143], v[92:95], v[152:155]
    s_waitcnt lgkmcnt(0)
    v_min_u32 v2, v2, v3
    s_nop 0
    v_readfirstlane_b32 s61, v2
    s_nop 0
    s_cmp_ge_u32 s61, 2
    s_cbranch_scc0 L_notrdy_59
    ds_read_b128 v[204:207], v10 offset:4096
    ds_read_b128 v[208:211], v11 offset:4096
    ds_read_b128 v[212:215], v12 offset:4096
    ds_read_b128 v[216:219], v13 offset:4096
    v_mfma_f32_16x16x32_bf16 v[156:159], v[144:147], v[144:147], v[156:159]
    v_mfma_f32_16x16x32_bf16 v[160:163], v[144:147], v[48:51], v[160:163]
    v_mfma_f32_16x16x32_bf16 v[164:167], v[144:147], v[36:39], v[164:167]
    v_mfma_f32_16x16x32_bf16 v[152:155], v[144:147], v[96:99], v[152:155]
    v_mfma_f32_16x16x32_bf16 v[156:159], v[148:151], v[148:151], v[156:159]
    v_mfma_f32_16x16x32_bf16 v[160:163], v[148:151], v[52:55], v[160:163]
    v_mfma_f32_16x16x32_bf16 v[164:167], v[148:151], v[36:39], v[164:167]
    v_mfma_f32_16x16x32_bf16 v[152:155], v[148:151], v[100:103], v[152:155]
L_next_60:
    s_waitcnt lgkmcnt(3)
    v_mfma_f32_16x16x32_bf16 v[156:159], v[204:207], v[204:207], v[156:159]
    v_mfma_f32_16x16x32_bf16 v[160:163], v[204:207], v[56:59], v[160:163]
    v_mfma_f32_16x16x32_bf16 v[164:167], v[204:207], v[36:39], v[164:167]
    v_mfma_f32_16x16x32_bf16 v[152:155], v[204:207], v[104:107], v[152:155]
    ds_read_b64 v[2:3], v24 offset:240
    s_waitcnt lgkmcnt(3)
    v_mfma_f32_16x16x32_bf16 v[156:159], v[208:211], v[208:211], v[156:159]
    v_mfma_f32_16x16x32_bf16 v[160:163], v[208:211], v[60:63], v[160:163]
    v_mfma_f32_16x16x32_bf16 v[164:167], v[208:211], v[36:39], v[164:167]
    v_mfma_f32_16x16x32_bf16 v[152:155], v[208:211], v[108:111], v[152:155]
    s_waitcnt lgkmcnt(0)
    v_min_u32 v2, v2, v3
    s_nop 0
    v_readfirstlane_b32 s61, v2
    s_nop 0
    s_cmp_ge_u32 s61, 3
    s_cbranch_scc0 L_notrdy_61
    ds_read_b128 v[136:139], v10 offset:8192
    ds_read_b128 v[140:143], v11 offset:8192
    ds_read_b128 v[144:147], v12 offset:8192
    ds_read_b128 v[148:151], v13 offset:8192
    v_mfma_f32_16x16x32_bf16 v[156:159], v[212:215], v[212:215], v[156:159]
    v_mfma_f32_16x16x32_bf16 v[160:163], v[212:215], v[64:67], v[160:163]
    v_mfma_f32_16x16x32_bf16 v[164:167], v[212:215], v[36:39], v[164:167]
    v_mfma_f32_16x16x32_bf16 v[152:155], v[212:215], v[112:115], v[152:155]
    v_mfma_f32_16x16x32_bf16 v[156:159], v[216:219], v[216:219], v[156:159]
    v_mfma_f32_16x16x32_bf16 v[160:163], v[216:219], v[68:71], v[160:163]
    v_mfma_f32_16x16x32_bf16 v[164:167], v[216:219], v[36:39], v[164:167]
    v_mfma_f32_16x16x32_bf16 v[152:155], v[216:219], v[116:119], v[152:155]
L_next_62:
    s_waitcnt lgkmcnt(3)
    v_mfma_f32_16x16x32_bf16 v[156:159], v[136:139], v[136:139], v[156:159]
    v_mfma_f32_16x16x32_bf16 v[160:163], v[136:139], v[72:75], v[160:163]
    v_mfma_f32_16x16x32_bf16 v[164:167], v[136:139], v[36:39], v[164:167]
    v_mfma_f32_16x16x32_bf16 v[152:155], v[136:139], v[120:123], v[152:155]
    s_waitcnt lgkmcnt(2)
    v_mfma_f32_16x16x32_bf16 v[156:159], v[140:143], v[140:143], v[156:159]
    v_mfma_f32_16x16x32_bf16 v[160:163], v[140:143], v[76:79], v[160:163]
    v_mfma_f32_16x16x32_bf16 v[164:167], v[140:143], v[36:39], v[164:167]
    v_mfma_f32_16x16x32_bf16 v[152:155], v[140:143], v[124:127], v[152:155]
    s_waitcnt lgkmcnt(1)
    v_mfma_f32_16x16x32_bf16 v[156:159], v[144:147], v[144:147], v[156:159]
    v_mfma_f32_16x16x32_bf16 v[160:163], v[144:147], v[80:83], v[160:163]
    v_mfma_f32_16x16x32_bf16 v[164:167], v[144:147], v[36:39], v[164:167]
    v_mfma_f32_16x16x32_bf16 v[152:155], v[144:147], v[128:131], v[152:155]
    s_waitcnt lgkmcnt(0)
    v_mfma_f32_16x16x32_bf16 v[156:159], v[148:151], v[148:151], v[156:159]
    v_mfma_f32_16x16x32_bf16 v[160:163], v[148:151], v[84:87], v[160:163]
    v_mfma_f32_16x16x32_bf16 v[164:167], v[148:151], v[36:39], v[164:167]
    v_mfma_f32_16x16x32_bf16 v[152:155], v[148:151], v[132:135], v[152:155]
    ds_read_b64_tr_b16 v[220:221], v14 offset:0
    ds_read_b64_tr_b16 v[222:223], v14 offset:12288
    ds_read_b64_tr_b16 v[224:225], v14 offset:24576
    ds_read_b64_tr_b16 v[226:227], v14 offset:36864
    ds_read_b64_tr_b16 v[228:229], v15 offset:0
    ds_read_b64_tr_b16 v[230:231], v15 offset:12288
    ds_read_b64_tr_b16 v[232:233], v15 offset:24576
    ds_read_b64_tr_b16 v[234:235], v15 offset:36864
    v_pk_fma_f32 v[156:157], v[160:161], s[96:97], v[156:157]
    v_pk_fma_f32 v[158:159], v[162:163], s[96:97], v[158:159]
    v_cndmask_b32 v2, v156, v157, s[4:5]
    v_cndmask_b32 v2, v2, v158, s[6:7]
    v_cndmask_b32 v2, v2, v159, s[8:9]
    v_pk_mul_f32 v[156:157], v[164:165], s[52:53]
    v_pk_mul_f32 v[158:159], v[166:167], s[52:53]
    v_mov_b32 v3, v2
    s_nop 1
    v_mov_b32_dpp v3, v2 row_ror:12 row_mask:0x2 bank_mask:0xf
    s_nop 1
    v_mov_b32_dpp v3, v2 row_ror:8 row_mask:0x4 bank_mask:0xf
    s_nop 1
    v_mov_b32_dpp v3, v2 row_ror:4 row_mask:0x8 bank_mask:0xf
    v_pk_mul_f32 v[164:165], v[156:157], v[156:157]
    v_pk_mul_f32 v[166:167], v[158:159], v[158:159]
    v_mov_b32_dpp v240, v3 row_newbcast:0 row_mask:0xf bank_mask:0xf
    v_mov_b32_dpp v241, v3 row_newbcast:1 row_mask:0xf bank_mask:0xf
    v_mov_b32_dpp v242, v3 row_newbcast:2 row_mask:0xf bank_mask:0xf
    v_mov_b32_dpp v243, v3 row_newbcast:3 row_mask:0xf bank_mask:0xf
    ds_read_b64_tr_b16 v[244:245], v16 offset:0
    ds_read_b64_tr_b16 v[246:247], v16 offset:12288
    ds_read_b64_tr_b16 v[248:249], v16 offset:24576
    ds_read_b64_tr_b16 v[250:251], v16 offset:36864
    ds_read_b64_tr_b16 v[252:253], v17 offset:0
    ds_read_b64_tr_b16 v[254:255], v17 offset:12288
    v_pk_fma_f32 v[240:241], v[240:241], s[52:53], v[164:165] neg_lo:[0,0,1] neg_hi:[0,0,1]
    v_pk_fma_f32 v[242:243], v[242:243], s[52:53], v[166:167] neg_lo:[0,0,1] neg_hi:[0,0,1]
    v_add_f32 v240, s98, abs(v240)
    v_add_f32 v241, s98, abs(v241)
    v_add_f32 v242, s98, abs(v242)
    v_add_f32 v243, s98, abs(v243)
    v_rsq_f32 v240, v240
    v_rsq_f32 v241, v241
    v_rsq_f32 v242, v242
    v_rsq_f32 v243, v243
    v_pk_fma_f32 v[152:153], v[156:157], v[26:27], v[152:153] op_sel_hi:[1,0,1] neg_lo:[1,0,0] neg_hi:[1,0,0]
    v_pk_fma_f32 v[154:155], v[158:159], v[26:27], v[154:155] op_sel_hi:[1,0,1] neg_lo:[1,0,0] neg_hi:[1,0,0]
    v_pk_mul_f32 v[236:237], v[152:153], v[240:241]
    v_pk_mul_f32 v[238:239], v[154:155], v[242:243]
    v_add_u32 v10, 4294918144, v10
    v_add_u32 v11, 4294918144, v11
    v_add_u32 v12, 4294918144, v12
    v_add_u32 v13, 4294918144, v13
    v_and_b32 v2, 15, v0
    v_lshrrev_b32 v3, 4, v0
    v_lshrrev_b32 v4, 2, v2
    v_and_b32 v2, 3, v2
    v_lshlrev_b32 v1, 20, v4
    v_lshlrev_b32 v3, 16, v3
    v_add_u32 v1, v1, v3
    v_lshlrev_b32 v2, 4, v2
    v_add_u32 v1, v1, v2
    s_lshl_b32 s40, s3, 18
    s_lshl_b32 s43, s2, 6
    s_add_u32 s40, s40, s43
    s_add_u32 s40, s40, 1048576
    v_and_b32 v6, 15, v0
    v_lshlrev_b32 v6, 6, v6
    v_lshrrev_b32 v7, 4, v0
    v_lshlrev_b32 v7, 2, v7
    s_lshl_b32 s42, s3, 4
    s_add_u32 s42, s42, 158720
    v_add3_u32 v6, v6, v7, s42
    v_mov_b32 v27, v6
    s_waitcnt lgkmcnt(0)
L_spin_63:
    ds_read_b32 v2, v24 offset:0
    s_waitcnt lgkmcnt(0)
    v_readfirstlane_b32 s61, v2
    s_nop 0
    s_cmp_ge_u32 s61, 10
    s_cbranch_scc0 L_retry_65
L_done_64:
    ds_read_b128 v[136:139], v10 offset:0
    ds_read_b128 v[140:143], v11 offset:0
    ds_read_b128 v[144:147], v12 offset:0
    ds_read_b128 v[148:151], v13 offset:0
    s_waitcnt lgkmcnt(3)
    v_mfma_f32_16x16x32_bf16 v[156:159], v[136:139], v[136:139], v[176:179]
    v_mfma_f32_16x16x32_bf16 v[160:163], v[136:139], v[40:43], 0
    v_mfma_f32_16x16x32_bf16 v[164:167], v[136:139], v[36:39], v[172:175]
    v_mfma_f32_16x16x32_bf16 v[152:155], v[136:139], v[88:91], v[168:171]
    ds_read_b32 v2, v24 offset:0
    s_waitcnt lgkmcnt(3)
    v_mfma_f32_16x16x32_bf16 v[156:159], v[140:143], v[140:143], v[156:159]
    v_mfma_f32_16x16x32_bf16 v[160:163], v[140:143], v[44:47], v[160:163]
    v_mfma_f32_16x16x32_bf16 v[164:167], v[140:143], v[36:39], v[164:167]
    v_mfma_f32_16x16x32_bf16 v[152:155], v[140:143], v[92:95], v[152:155]
    s_waitcnt lgkmcnt(0)
    v_readfirstlane_b32 s61, v2
    s_nop 0
    s_cmp_ge_u32 s61, 11
    s_cbranch_scc0 L_notrdy_66
    ds_read_b128 v[204:207], v10 offset:4096
    ds_read_b128 v[208:211], v11 offset:4096
    ds_read_b128 v[212:215], v12 offset:4096
    ds_read_b128 v[216:219], v13 offset:4096
    v_mfma_f32_16x16x32_bf16 v[156:159], v[144:147], v[144:147], v[156:159]
    v_mfma_f32_16x16x32_bf16 v[160:163], v[144:147], v[48:51], v[160:163]
    v_mfma_f32_16x16x32_bf16 v[164:167], v[144:147], v[36:39], v[164:167]
    v_mfma_f32_16x16x32_bf16 v[152:155], v[144:147], v[96:99], v[152:155]
    v_mfma_f32_16x16x32_bf16 v[156:159], v[148:151], v[148:151], v[156:159]
    v_mfma_f32_16x16x32_bf16 v[160:163], v[148:151], v[52:55], v[160:163]
    v_mfma_f32_16x16x32_bf16 v[164:167], v[148:151], v[36:39], v[164:167]
    v_mfma_f32_16x16x32_bf16 v[152:155], v[148:151], v[100:103], v[152:155]
L_next_67:
    s_waitcnt lgkmcnt(3)
    v_mfma_f32_16x16x32_bf16 v[156:159], v[204:207], v[204:207], v[156:159]
    v_mfma_f32_16x16x32_bf16 v[160:163], v[204:207], v[56:59], v[160:163]
    v_mfma_f32_16x16x32_bf16 v[164:167], v[204:207], v[36:39], v[164:167]
    v_mfma_f32_16x16x32_bf16 v[152:155], v[204:207], v[104:107], v[152:155]
    ds_read_b32 v2, v24 offset:0
    s_waitcnt lgkmcnt(3)
    v_mfma_f32_16x16x32_bf16 v[156:159], v[208:211], v[208:211], v[156:159]
    v_mfma_f32_16x16x32_bf16 v[160:163], v[208:211], v[60:63], v[160:163]
    v_mfma_f32_16x16x32_bf16 v[164:167], v[208:211], v[36:39], v[164:167]
    v_mfma_f32_16x16x32_bf16 v[152:155], v[208:211], v[108:111], v[152:155]
    s_waitcnt lgkmcnt(0)
    v_readfirstlane_b32 s61, v2
    s_nop 0
    s_cmp_ge_u32 s61, 12
    s_cbranch_scc0 L_notrdy_68
    ds_read_b128 v[136:139], v10 offset:8192
    ds_read_b128 v[140:143], v11 offset:8192
    ds_read_b128 v[144:147], v12 offset:8192
    ds_read_b128 v[148:151], v13 offset:8192
    v_mfma_f32_16x16x32_bf16 v[156:159], v[212:215], v[212:215], v[156:159]
    v_mfma_f32_16x16x32_bf16 v[160:163], v[212:215], v[64:67], v[160:163]
    v_mfma_f32_16x16x32_bf16 v[164:167], v[212:215], v[36:39], v[164:167]
    v_mfma_f32_16x16x32_bf16 v[152:155], v[212:215], v[112:115], v[152:155]
    v_mfma_f32_16x16x32_bf16 v[156:159], v[216:219], v[216:219], v[156:159]
    v_mfma_f32_16x16x32_bf16 v[160:163], v[216:219], v[68:71], v[160:163]
    v_mfma_f32_16x16x32_bf16 v[164:167], v[216:219], v[36:39], v[164:167]
    v_mfma_f32_16x16x32_bf16 v[152:155], v[216:219], v[116:119], v[152:155]
L_next_69:
    s_waitcnt lgkmcnt(3)
    v_mfma_f32_16x16x32_bf16 v[156:159], v[136:139], v[136:139], v[156:159]
    v_mfma_f32_16x16x32_bf16 v[160:163], v[136:139], v[72:75], v[160:163]
    v_mfma_f32_16x16x32_bf16 v[164:167], v[136:139], v[36:39], v[164:167]
    v_mfma_f32_16x16x32_bf16 v[152:155], v[136:139], v[120:123], v[152:155]
    s_waitcnt lgkmcnt(2)
    v_mfma_f32_16x16x32_bf16 v[156:159], v[140:143], v[140:143], v[156:159]
    v_mfma_f32_16x16x32_bf16 v[160:163], v[140:143], v[76:79], v[160:163]
    v_mfma_f32_16x16x32_bf16 v[164:167], v[140:143], v[36:39], v[164:167]
    v_mfma_f32_16x16x32_bf16 v[152:155], v[140:143], v[124:127], v[152:155]
    s_waitcnt lgkmcnt(1)
    v_mfma_f32_16x16x32_bf16 v[156:159], v[144:147], v[144:147], v[156:159]
    v_mfma_f32_16x16x32_bf16 v[160:163], v[144:147], v[80:83], v[160:163]
    v_mfma_f32_16x16x32_bf16 v[164:167], v[144:147], v[36:39], v[164:167]
    v_mfma_f32_16x16x32_bf16 v[152:155], v[144:147], v[128:131], v[152:155]
    s_waitcnt lgkmcnt(0)
    v_mfma_f32_16x16x32_bf16 v[156:159], v[148:151], v[148:151], v[156:159]
    v_mfma_f32_16x16x32_bf16 v[160:163], v[148:151], v[84:87], v[160:163]
    v_mfma_f32_16x16x32_bf16 v[164:167], v[148:151], v[36:39], v[164:167]
    v_mfma_f32_16x16x32_bf16 v[152:155], v[148:151], v[132:135], v[152:155]
    ds_read_b64_tr_b16 v[40:41], v17 offset:24576
    ds_read_b64_tr_b16 v[42:43], v17 offset:36864
    ds_read_b64_tr_b16 v[44:45], v18 offset:0
    ds_read_b64_tr_b16 v[46:47], v18 offset:12288
    ds_read_b64_tr_b16 v[48:49], v18 offset:24576
    ds_read_b64_tr_b16 v[50:51], v18 offset:36864
    ds_read_b64_tr_b16 v[52:53], v19 offset:0
    ds_read_b64_tr_b16 v[54:55], v19 offset:12288
    ds_read_b64_tr_b16 v[56:57], v19 offset:24576
    ds_read_b64_tr_b16 v[58:59], v19 offset:36864
    v_add_u32 v14, 4294918144, v14
    v_add_u32 v15, 4294918144, v15
    v_add_u32 v16, 4294918144, v16
    v_add_u32 v17, 4294918144, v17
    v_add_u32 v18, 4294918144, v18
    v_add_u32 v19, 4294918144, v19
    v_pk_fma_f32 v[156:157], v[160:161], s[96:97], v[156:157]
    v_pk_fma_f32 v[158:159], v[162:163], s[96:97], v[158:159]
    v_cndmask_b32 v2, v156, v157, s[4:5]
    v_cndmask_b32 v2, v2, v158, s[6:7]
    v_cndmask_b32 v2, v2, v159, s[8:9]
    v_pk_mul_f32 v[156:157], v[164:165], s[52:53]
    v_pk_mul_f32 v[158:159], v[166:167], s[52:53]
    v_mov_b32 v3, v2
    s_nop 1
    v_mov_b32_dpp v3, v2 row_ror:12 row_mask:0x2 bank_mask:0xf
    s_nop 1
    v_mov_b32_dpp v3, v2 row_ror:8 row_mask:0x4 bank_mask:0xf
    s_nop 1
    v_mov_b32_dpp v3, v2 row_ror:4 row_mask:0x8 bank_mask:0xf
    v_pk_mul_f32 v[164:165], v[156:157], v[156:157]
    v_pk_mul_f32 v[166:167], v[158:159], v[158:159]
    v_mov_b32_dpp v160, v3 row_newbcast:0 row_mask:0xf bank_mask:0xf
    v_mov_b32_dpp v161, v3 row_newbcast:1 row_mask:0xf bank_mask:0xf
    v_mov_b32_dpp v162, v3 row_newbcast:2 row_mask:0xf bank_mask:0xf
    v_mov_b32_dpp v163, v3 row_newbcast:3 row_mask:0xf bank_mask:0xf
    ds_read_b64_tr_b16 v[88:89], v14 offset:0
    ds_read_b64_tr_b16 v[90:91], v14 offset:12288
    ds_read_b64_tr_b16 v[92:93], v14 offset:24576
    ds_read_b64_tr_b16 v[94:95], v14 offset:36864
    ds_read_b64_tr_b16 v[96:97], v15 offset:0
    ds_read_b64_tr_b16 v[98:99], v15 offset:12288
    ds_read_b64_tr_b16 v[100:101], v15 offset:24576
    ds_read_b64_tr_b16 v[102:103], v15 offset:36864
    ds_read_b64_tr_b16 v[104:105], v16 offset:0
    ds_read_b64_tr_b16 v[106:107], v16 offset:12288
    ds_read_b64_tr_b16 v[108:109], v16 offset:24576
    ds_read_b64_tr_b16 v[110:111], v16 offset:36864
    v_pk_fma_f32 v[160:161], v[160:161], s[52:53], v[164:165] neg_lo:[0,0,1] neg_hi:[0,0,1]
    v_pk_fma_f32 v[162:163], v[162:163], s[52:53], v[166:167] neg_lo:[0,0,1] neg_hi:[0,0,1]
    v_add_f32 v160, s98, abs(v160)
    v_add_f32 v161, s98, abs(v161)
    v_add_f32 v162, s98, abs(v162)
    v_add_f32 v163, s98, abs(v163)
    v_rsq_f32 v160, v160
    v_rsq_f32 v161, v161
    v_rsq_f32 v162, v162
    v_rsq_f32 v163, v163
    ds_read_b64_tr_b16 v[112:113], v17 offset:0
    ds_read_b64_tr_b16 v[114:115], v17 offset:12288
    ds_read_b64_tr_b16 v[116:117], v17 offset:24576
    ds_read_b64_tr_b16 v[118:119], v17 offset:36864
    ds_read_b64_tr_b16 v[120:121], v18 offset:0
    ds_read_b64_tr_b16 v[122:123], v18 offset:12288
    v_pk_fma_f32 v[152:153], v[156:157], v[26:27], v[152:153] op_sel_hi:[1,0,1] neg_lo:[1,0,0] neg_hi:[1,0,0]
    v_pk_fma_f32 v[154:155], v[158:159], v[26:27], v[154:155] op_sel_hi:[1,0,1] neg_lo:[1,0,0] neg_hi:[1,0,0]
    v_pk_mul_f32 v[152:153], v[152:153], v[160:161]
    v_pk_mul_f32 v[154:155], v[154:155], v[162:163]
    v_pk_add_f32 v[212:213], v[236:237], v[28:29] op_sel_hi:[1,0] neg_lo:[0,1] neg_hi:[0,1]
    v_pk_add_f32 v[214:215], v[238:239], v[28:29] op_sel_hi:[1,0] neg_lo:[0,1] neg_hi:[0,1]
    v_pk_add_f32 v[156:157], v[152:153], v[28:29] op_sel_hi:[1,0] neg_lo:[0,1] neg_hi:[0,1]
    v_pk_add_f32 v[158:159], v[154:155], v[28:29] op_sel_hi:[1,0] neg_lo:[0,1] neg_hi:[0,1]
    v_max3_f32 v2, v156, v157, v158
    v_max3_f32 v2, v2, v159, v212
    v_max3_f32 v2, v2, v213, v214
    v_max_f32 v2, v2, v215
    v_cmp_lt_f32 vcc, s99, v2
    v_exp_f32 v156, v156
    v_exp_f32 v157, v157
    v_exp_f32 v158, v158
    v_exp_f32 v159, v159
    v_exp_f32 v212, v212
    v_exp_f32 v213, v213
    v_exp_f32 v214, v214
    v_exp_f32 v215, v215
    s_cmp_lg_u64 vcc, 0
    s_cselect_b32 s60, 2, 1
    v_pk_mul_f32 v[164:165], v[156:157], v[160:161]
    v_pk_mul_f32 v[166:167], v[158:159], v[162:163]
    v_pk_mul_f32 v[216:217], v[212:213], v[240:241]
    v_pk_mul_f32 v[218:219], v[214:215], v[242:243]
    v_cvt_pk_bf16_f32 v30, v164, v165
    v_cvt_pk_bf16_f32 v31, v166, v167
    v_cvt_pk_bf16_f32 v8, v216, v217
    v_cvt_pk_bf16_f32 v9, v218, v219
    ds_write_b64 v20, v[30:31] offset:6144
    ds_write_b64 v20, v[8:9] offset:4096
    v_pk_add_f32 v[216:217], v[216:217], v[32:33]
    v_pk_add_f32 v[218:219], v[218:219], v[34:35]
    v_pk_add_f32 v[216:217], v[216:217], v[164:165]
    v_pk_add_f32 v[218:219], v[218:219], v[166:167]
    v_cvt_pk_bf16_f32 v2, v216, v217
    v_cvt_pk_bf16_f32 v3, v218, v219
    ds_write_b64 v20, v[2:3] offset:8192
    v_pk_add_f32 v[212:213], v[212:213], v[156:157]
    v_pk_add_f32 v[214:215], v[214:215], v[158:159]
    v_add_f32 v212, v212, v213
    v_add_f32 v214, v214, v215
    v_add_f32 v212, v212, v214
    v_add_f32 v212, v212, v29
    ds_write_b32 v27, v212
    v_mov_b32 v4, s60
    ds_write_b32 v25, v4 offset:192
    ds_read_b64_tr_b16 v[124:125], v18 offset:24576
    ds_read_b64_tr_b16 v[126:127], v18 offset:36864
    ds_read_b64_tr_b16 v[128:129], v19 offset:0
    ds_read_b64_tr_b16 v[130:131], v19 offset:12288
    ds_read_b64_tr_b16 v[132:133], v19 offset:24576
    ds_read_b64_tr_b16 v[134:135], v19 offset:36864
    v_add_u32 v14, 98304, v14
    v_add_u32 v15, 98304, v15
    v_add_u32 v16, 98304, v16
    v_add_u32 v17, 98304, v17
    v_add_u32 v18, 98304, v18
    v_add_u32 v19, 98304, v19
L_xsp_70:
    ds_read_b128 v[2:5], v24 offset:192
    ds_read_b64 v[8:9], v24 offset:280
    ds_read2st64_b64 v[136:139], v21 offset0:8 offset1:9
    ds_read2st64_b64 v[140:143], v21 offset0:10 offset1:11
    ds_read2st64_b64 v[144:147], v21 offset0:12 offset1:13
    ds_read2st64_b64 v[148:151], v21 offset0:14 offset1:15
    ds_read2st64_b64 v[204:207], v21 offset0:16 offset1:17
    ds_read2st64_b64 v[208:211], v21 offset0:18 offset1:19
    s_waitcnt lgkmcnt(7)
    v_min3_u32 v7, v2, v3, v4
    v_min_u32 v7, v7, v5
    s_waitcnt lgkmcnt(6)
    v_min3_u32 v7, v7, v8, v9
    v_max3_u32 v2, v2, v3, v4
    v_max_u32 v2, v2, v5
    v_readfirstlane_b32 s61, v7
    v_readfirstlane_b32 s60, v2
    s_cmp_ge_u32 s61, 1
    s_cbranch_scc0 L_xretry_72
L_xok_71:
    s_waitcnt lgkmcnt(0)
    s_cmp_ge_u32 s60, 2
    s_cbranch_scc1 L_slow_73
L_go_74:
    s_and_b32 s50, s54, 0xffff
    s_mov_b32 s51, 0xffff
    v_lshrrev_b32 v8, 16, v28
    v_xor_b32 v8, s50, v8
    v_mfma_f32_16x16x32_bf16 v[180:183], v[220:223], v[136:139], v[180:183]
    ds_read_b64_tr_b16 v[220:221], v14 offset:0
    ds_read_b64_tr_b16 v[222:223], v14 offset:12288
    v_mfma_f32_16x16x32_bf16 v[180:183], v[224:227], v[140:143], v[180:183]
    ds_read_b64_tr_b16 v[224:225], v14 offset:24576
    ds_read_b64_tr_b16 v[226:227], v14 offset:36864
    v_mfma_f32_16x16x32_bf16 v[184:187], v[228:231], v[136:139], v[184:187]
    ds_read_b64_tr_b16 v[228:229], v15 offset:0
    ds_read_b64_tr_b16 v[230:231], v15 offset:12288
    v_mfma_f32_16x16x32_bf16 v[184:187], v[232:235], v[140:143], v[184:187]
    ds_read_b64_tr_b16 v[232:233], v15 offset:24576
    ds_read_b64_tr_b16 v[234:235], v15 offset:36864
    v_mfma_f32_16x16x32_bf16 v[188:191], v[244:247], v[136:139], v[188:191]
    ds_read_b64_tr_b16 v[244:245], v16 offset:0
    ds_read_b64_tr_b16 v[246:247], v16 offset:12288
    v_mfma_f32_16x16x32_bf16 v[188:191], v[248:251], v[140:143], v[188:191]
    ds_read_b64_tr_b16 v[248:249], v16 offset:24576
    ds_read_b64_tr_b16 v[250:251], v16 offset:36864
    v_mfma_f32_16x16x32_bf16 v[192:195], v[252:255], v[136:139], v[192:195]
    ds_read_b64_tr_b16 v[252:253], v17 offset:0
    ds_read_b64_tr_b16 v[254:255], v17 offset:12288
    v_mfma_f32_16x16x32_bf16 v[192:195], v[40:43], v[140:143], v[192:195]
    ds_read_b64_tr_b16 v[40:41], v17 offset:24576
    ds_read_b64_tr_b16 v[42:43], v17 offset:36864
    v_mfma_f32_16x16x32_bf16 v[196:199], v[44:47], v[136:139], v[196:199]
    ds_read_b64_tr_b16 v[44:45], v18 offset:0
    ds_read_b64_tr_b16 v[46:47], v18 offset:12288
    v_mfma_f32_16x16x32_bf16 v[196:199], v[48:51], v[140:143], v[196:199]
    ds_read_b64_tr_b16 v[48:49], v18 offset:24576
    ds_read_b64_tr_b16 v[50:51], v18 offset:36864
    v_mfma_f32_16x16x32_bf16 v[200:203], v[52:55], v[136:139], v[200:203]
    ds_read_b64_tr_b16 v[52:53], v19 offset:0
    ds_read_b64_tr_b16 v[54:55], v19 offset:12288
    v_mfma_f32_16x16x32_bf16 v[200:203], v[56:59], v[140:143], v[200:203]
    ds_read_b64_tr_b16 v[56:57], v19 offset:24576
    ds_read_b64_tr_b16 v[58:59], v19 offset:36864
    v_mfma_f32_16x16x32_bf16 v[180:183], v[88:91], v[144:147], v[180:183]
    v_mfma_f32_16x16x32_bf16 v[180:183], v[92:95], v[148:151], v[180:183]
    v_mfma_f32_16x16x32_bf16 v[184:187], v[96:99], v[144:147], v[184:187]
    v_mfma_f32_16x16x32_bf16 v[184:187], v[100:103], v[148:151], v[184:187]
    v_mfma_f32_16x16x32_bf16 v[188:191], v[104:107], v[144:147], v[188:191]
    v_mfma_f32_16x16x32_bf16 v[188:191], v[108:111], v[148:151], v[188:191]
    v_mfma_f32_16x16x32_bf16 v[192:195], v[112:115], v[144:147], v[192:195]
    v_mfma_f32_16x16x32_bf16 v[192:195], v[116:119], v[148:151], v[192:195]
    v_mfma_f32_16x16x32_bf16 v[196:199], v[120:123], v[144:147], v[196:199]
    v_mfma_f32_16x16x32_bf16 v[196:199], v[124:127], v[148:151], v[196:199]
    v_mfma_f32_16x16x32_bf16 v[200:203], v[128:131], v[144:147], v[200:203]
    v_mfma_f32_16x16x32_bf16 v[200:203], v[132:135], v[148:151], v[200:203]
    s_waitcnt lgkmcnt(15)
    v_mfma_f32_16x16x32_bf16 v[180:183], v[220:223], v[204:207], v[180:183]
    v_mfma_f32_16x16x32_bf16 v[180:183], v[224:227], v[208:211], v[180:183]
    v_mfma_f32_16x16x32_bf16 v[184:187], v[228:231], v[204:207], v[184:187]
    v_mfma_f32_16x16x32_bf16 v[184:187], v[232:235], v[208:211], v[184:187]
    s_waitcnt lgkmcnt(14)
    v_mfma_f32_16x16x32_bf16 v[188:191], v[244:247], v[204:207], v[188:191]
    s_waitcnt lgkmcnt(12)
    v_mfma_f32_16x16x32_bf16 v[188:191], v[248:251], v[208:211], v[188:191]
    s_waitcnt lgkmcnt(10)
    v_mfma_f32_16x16x32_bf16 v[192:195], v[252:255], v[204:207], v[192:195]
    s_waitcnt lgkmcnt(8)
    v_mfma_f32_16x16x32_bf16 v[192:195], v[40:43], v[208:211], v[192:195]
    v_cvt_pk_bf16_f32 v64, v180, v181
    v_cvt_pk_bf16_f32 v65, v182, v183
    v_cvt_pk_bf16_f32 v66, v184, v185
    v_bitop3_b32 v67, v64, v65, v66 bitop3:0x96
    v_lshrrev_b32 v9, 16, v67
    v_bitop3_b32 v67, v67, v9, v8 bitop3:0x96
    v_bfi_b32 v67, s51, v67, v28
    buffer_store_dwordx4 v[64:67], v1, s[32:35], s40 offen sc1
    s_add_u32 s40, s40, 16384
    s_waitcnt lgkmcnt(6)
    v_mfma_f32_16x16x32_bf16 v[196:199], v[44:47], v[204:207], v[196:199]
    s_waitcnt lgkmcnt(4)
    v_mfma_f32_16x16x32_bf16 v[196:199], v[48:51], v[208:211], v[196:199]
    v_cvt_pk_bf16_f32 v68, v186, v187
    v_cvt_pk_bf16_f32 v69, v188, v189
    v_cvt_pk_bf16_f32 v70, v190, v191
    v_bitop3_b32 v71, v68, v69, v70 bitop3:0x96
    v_lshrrev_b32 v9, 16, v71
    v_bitop3_b32 v71, v71, v9, v8 bitop3:0x96
    v_bfi_b32 v71, s51, v71, v28
    buffer_store_dwordx4 v[68:71], v1, s[32:35], s40 offen sc1
    s_add_u32 s40, s40, 16384
    s_waitcnt lgkmcnt(2)
    v_mfma_f32_16x16x32_bf16 v[200:203], v[52:55], v[204:207], v[200:203]
    s_waitcnt lgkmcnt(0)
    v_mfma_f32_16x16x32_bf16 v[200:203], v[56:59], v[208:211], v[200:203]
    v_cvt_pk_bf16_f32 v72, v192, v193
    v_cvt_pk_bf16_f32 v73, v194, v195
    v_cvt_pk_bf16_f32 v74, v196, v197
    v_bitop3_b32 v75, v72, v73, v74 bitop3:0x96
    v_lshrrev_b32 v9, 16, v75
    v_bitop3_b32 v75, v75, v9, v8 bitop3:0x96
    v_bfi_b32 v75, s51, v75, v28
    buffer_store_dwordx4 v[72:75], v1, s[32:35], s40 offen sc1
    s_add_u32 s40, s40, 16384
    v_cvt_pk_bf16_f32 v76, v198, v199
    v_cvt_pk_bf16_f32 v77, v200, v201
    v_cvt_pk_bf16_f32 v78, v202, v203
    v_bitop3_b32 v79, v76, v77, v78 bitop3:0x96
    v_lshrrev_b32 v9, 16, v79
    v_bitop3_b32 v79, v79, v9, v8 bitop3:0x96
    v_bfi_b32 v79, s51, v79, v28
    buffer_store_dwordx4 v[76:79], v1, s[32:35], s40 offen sc1
    v_and_b32 v1, 15, v0
    v_lshrrev_b32 v3, 2, v1
    v_and_b32 v4, 3, v1
    s_cmp_lg_u32 s3, 0
    s_cbranch_scc1 L_skipml_75
    v_lshlrev_b32 v6, 6, v1
    v_add_u32 v6, 158720, v6
    ds_read_b128 v[240:243], v6 offset:0
    ds_read_b128 v[244:247], v6 offset:16
    ds_read_b128 v[248:251], v6 offset:32
    ds_read_b128 v[252:255], v6 offset:48
    s_waitcnt lgkmcnt(3)
    v_add_f32 v240, v240, v241
    v_add_f32 v242, v242, v243
    s_waitcnt lgkmcnt(2)
    v_add_f32 v244, v244, v245
    v_add_f32 v246, v246, v247
    s_waitcnt lgkmcnt(1)
    v_add_f32 v248, v248, v249
    v_add_f32 v250, v250, v251
    s_waitcnt lgkmcnt(0)
    v_add_f32 v252, v252, v253
    v_add_f32 v254, v254, v255
    v_add_f32 v240, v240, v242
    v_add_f32 v244, v244, v246
    v_add_f32 v248, v248, v250
    v_add_f32 v252, v252, v254
    v_add_f32 v240, v240, v244
    v_add_f32 v248, v248, v252
    v_add_f32 v237, v240, v248
    v_mov_b32 v236, v28
    v_mov_b32 v238, 0
    v_bitop3_b32 v239, v236, v237, v238 bitop3:0x96
    v_xor_b32 v239, s54, v239
    v_lshlrev_b32 v6, 14, v3
    v_lshlrev_b32 v7, 4, v4
    v_add_u32 v6, v6, v7
    s_lshl_b32 s43, s2, 6
    s_add_u32 s43, s43, 524288
    s_mov_b64 exec, 0xffff
    buffer_store_dwordx4 v[236:239], v6, s[32:35], s43 offen sc1
    s_mov_b64 exec, -1
L_skipml_75:
    s_lshl_b32 s45, s2, 14
    s_lshl_b32 s46, s3, 12
    s_add_u32 s45, s45, s46
    s_add_u32 s45, s45, 1048576
    s_lshr_b32 s43, s2, 6
    v_lshlrev_b32 v1, 4, v0
    v_lshrrev_b32 v6, 4, v0
    v_and_b32 v7, 3, v0
    v_lshlrev_b32 v8, 2, v6
    v_add_u32 v8, v8, v7
    v_lshlrev_b32 v8, 3, v8
    v_add_u32 v90, 160768, v8
    s_lshl_b32 s47, s3, 7
    v_add_u32 v88, s47, v90
    v_lshlrev_b32 v8, 2, v7
    v_add_u32 v91, 161280, v8
    s_lshl_b32 s47, s3, 4
    v_add_u32 v89, s47, v91
    v_lshlrev_b32 v7, 4, v7
    v_lshlrev_b32 v6, 2, v6
    v_add_u32 v92, v7, v6
    s_bfe_u32 s47, s2, 0x20004
    s_lshl_b32 s47, s47, 2
    s_and_b32 s48, s2, 3
    s_add_u32 s47, s47, s48
    s_lshl_b32 s47, s47, 6
    s_bfe_u32 s48, s2, 0x20002
    s_lshl_b32 s48, s48, 4
    s_add_u32 s47, s47, s48
    s_lshl_b32 s48, s43, 2
    s_add_u32 s47, s47, s48
    s_lshl_b32 s47, s47, 4
    s_add_u32 s47, s47, 36864
    v_and_b32 v6, 12, v0
    v_cmp_eq_u32 s[48:49], 0, v6
    v_cmp_le_u32 s[40:41], 48, v0
    v_mov_b32 v80, 0
    v_mov_b32 v81, 0
    v_mov_b32 v82, 0
    v_mov_b32 v83, 0
    v_mov_b32 v84, 0
    v_mov_b32 v85, 0
    v_mov_b32 v86, 0
    v_mov_b32 v87, 0
L_spin_76:
    ds_read_b32 v2, v24 offset:304
    s_waitcnt lgkmcnt(0)
    v_readfirstlane_b32 s61, v2
    s_nop 0
    s_cmp_ge_u32 s61, 1
    s_cbranch_scc0 L_retry_78
L_done_77:
    s_and_b32 s50, s54, 0xffff
    s_mov_b32 s51, 0xffff
L_pg16_79:
    buffer_load_dwordx4 v[40:43], v1, s[32:35], s45 offen offset:0 sc1
    buffer_load_dwordx4 v[44:47], v1, s[32:35], s45 offen offset:1024 sc1
    buffer_load_dwordx4 v[48:51], v1, s[32:35], s45 offen offset:2048 sc1
    buffer_load_dwordx4 v[52:55], v1, s[32:35], s45 offen offset:3072 sc1
    s_waitcnt vmcnt(3)
    v_bitop3_b32 v4, v40, v41, v42 bitop3:0x96
    v_xor_b32 v4, v4, v43
    v_lshrrev_b32 v6, 16, v4
    v_bitop3_b32 v4, v4, v6, s50 bitop3:0x96
    v_and_b32 v5, s51, v4
    s_waitcnt vmcnt(2)
    v_bitop3_b32 v4, v44, v45, v46 bitop3:0x96
    v_xor_b32 v4, v4, v47
    v_lshrrev_b32 v6, 16, v4
    v_bitop3_b32 v4, v4, v6, s50 bitop3:0x96
    v_bitop3_b32 v5, v4, v5, s51 bitop3:0xec
    s_waitcnt vmcnt(1)
    v_bitop3_b32 v4, v48, v49, v50 bitop3:0x96
    v_xor_b32 v4, v4, v51
    v_lshrrev_b32 v6, 16, v4
    v_bitop3_b32 v4, v4, v6, s50 bitop3:0x96
    v_bitop3_b32 v5, v4, v5, s51 bitop3:0xec
    s_waitcnt vmcnt(0)
    v_bitop3_b32 v4, v52, v53, v54 bitop3:0x96
    v_xor_b32 v4, v4, v55
    v_lshrrev_b32 v6, 16, v4
    v_bitop3_b32 v4, v4, v6, s50 bitop3:0x96
    v_bitop3_b32 v5, v4, v5, s51 bitop3:0xec
    s_nop 1
    v_or_b32_dpp v5, v5, v5 quad_perm:[1,0,3,2] row_mask:0xf bank_mask:0xf
    s_nop 1
    v_or_b32_dpp v5, v5, v5 quad_perm:[2,3,0,1] row_mask:0xf bank_mask:0xf
    v_cmp_ne_u32 vcc, 0, v5
    s_nop 0
    s_and_b64 exec, exec, vcc
    s_cbranch_execz L_pg16d_80
    s_sub_u32 s55, s55, 1
    s_cbranch_scc0 L_pg16_79
    s_mov_b32 s55, 0
L_pg16d_80:
    s_mov_b64 exec, -1
    v_and_b32 v56, 0xffff0000, v43
    v_and_b32 v57, 0xffff0000, v47
    v_and_b32 v58, 0xffff0000, v51
    v_and_b32 v59, 0xffff0000, v55
    v_max3_f32 v3, v56, v57, v58
    v_max_f32 v3, v3, v59
    s_nop 1
    v_max_f32_dpp v3, v3, v3 row_ror:4 row_mask:0xf bank_mask:0xf
    s_nop 1
    v_max_f32_dpp v3, v3, v3 row_ror:8 row_mask:0xf bank_mask:0xf
    v_mov_b32 v4, v3
    s_nop 1
    v_permlane32_swap_b32 v4, v3
    v_max_f32 v3, v3, v4
    v_mov_b32 v4, v3
    s_nop 1
    v_permlane16_swap_b32 v4, v3
    v_max_f32 v3, v3, v4
    v_sub_f32 v56, v56, v3
    v_sub_f32 v57, v57, v3
    v_sub_f32 v58, v58, v3
    v_sub_f32 v59, v59, v3
    ds_write_b32 v89, v3
    v_exp_f32 v56, v56
    v_exp_f32 v57, v57
    v_exp_f32 v58, v58
    v_exp_f32 v59, v59
    v_cvt_pk_bf16_f32 v72, v56, 0
    v_cvt_pk_bf16_f32 v73, v57, 0
    v_cvt_pk_bf16_f32 v74, v58, 0
    v_cvt_pk_bf16_f32 v75, v59, 0
    v_lshlrev_b32 v76, 16, v72
    v_lshlrev_b32 v77, 16, v73
    v_lshlrev_b32 v78, 16, v74
    v_lshlrev_b32 v79, 16, v75
    v_dot2c_f32_bf16 v80, v40, v72
    v_dot2c_f32_bf16 v81, v40, v76
    v_dot2c_f32_bf16 v82, v41, v72
    v_dot2c_f32_bf16 v83, v41, v76
    v_dot2c_f32_bf16 v84, v42, v72
    v_dot2c_f32_bf16 v85, v42, v76
    v_dot2c_f32_bf16 v80, v44, v73
    v_dot2c_f32_bf16 v81, v44, v77
    v_dot2c_f32_bf16 v82, v45, v73
    v_dot2c_f32_bf16 v83, v45, v77
    v_dot2c_f32_bf16 v84, v46, v73
    v_dot2c_f32_bf16 v85, v46, v77
    v_dot2c_f32_bf16 v80, v48, v74
    v_dot2c_f32_bf16 v81, v48, v78
    v_dot2c_f32_bf16 v82, v49, v74
    v_dot2c_f32_bf16 v83, v49, v78
    v_dot2c_f32_bf16 v84, v50, v74
    v_dot2c_f32_bf16 v85, v50, v78
    v_dot2c_f32_bf16 v80, v52, v75
    v_dot2c_f32_bf16 v81, v52, v79
    v_dot2c_f32_bf16 v82, v53, v75
    v_dot2c_f32_bf16 v83, v53, v79
    v_dot2c_f32_bf16 v84, v54, v75
    v_dot2c_f32_bf16 v85, v54, v79
    s_nop 1
    v_permlane32_swap_b32 v80, v84
    v_permlane32_swap_b32 v81, v85
    v_permlane32_swap_b32 v82, v86
    v_permlane32_swap_b32 v83, v87
    v_add_f32 v80, v80, v84
    v_add_f32 v81, v81, v85
    v_add_f32 v82, v82, v86
    v_add_f32 v83, v83, v87
    s_nop 0
    v_permlane16_swap_b32 v80, v82
    v_permlane16_swap_b32 v81, v83
    v_add_f32 v80, v80, v82
    v_add_f32 v81, v81, v83
    s_nop 0
    v_add_f32_dpp v80, v80, v80 row_ror:4 row_mask:0xf bank_mask:0xf
    v_add_f32_dpp v81, v81, v81 row_ror:4 row_mask:0xf bank_mask:0xf
    s_nop 0
    v_add_f32_dpp v80, v80, v80 row_ror:8 row_mask:0xf bank_mask:0xf
    v_add_f32_dpp v81, v81, v81 row_ror:8 row_mask:0xf bank_mask:0xf
    ds_write_b64 v88, v[80:81]
    v_mov_b32 v4, 1
    ds_write_b32 v25, v4 offset:96
    s_cmp_lg_u32 s3, 0
    s_cbranch_scc1 L_redx_81
L_rsp_82:
    ds_read_b128 v[4:7], v24 offset:96
    ds_read_b64 v[40:41], v90 offset:0
    ds_read_b32 v48, v91 offset:0
    ds_read_b64 v[42:43], v90 offset:128
    ds_read_b32 v49, v91 offset:16
    ds_read_b64 v[44:45], v90 offset:256
    ds_read_b32 v50, v91 offset:32
    ds_read_b64 v[46:47], v90 offset:384
    ds_read_b32 v51, v91 offset:48
    s_waitcnt lgkmcnt(8)
    v_min3_u32 v4, v4, v5, v6
    v_min_u32 v4, v4, v7
    s_nop 0
    v_readfirstlane_b32 s61, v4
    s_nop 0
    s_cmp_ge_u32 s61, 1
    s_cbranch_scc1 L_rspd_83
    s_sub_u32 s62, s62, 1
    s_cbranch_scc0 L_rsp_82
    s_mov_b32 s62, 0
L_rspd_83:
    s_waitcnt lgkmcnt(0)
    v_max3_f32 v3, v48, v49, v50
    v_max_f32 v3, v3, v51
    v_sub_f32 v48, v48, v3
    v_sub_f32 v49, v49, v3
    v_sub_f32 v50, v50, v3
    v_sub_f32 v51, v51, v3
    v_exp_f32 v48, v48
    v_exp_f32 v49, v49
    v_exp_f32 v50, v50
    v_exp_f32 v51, v51
    v_mul_f32 v8, v40, v48
    v_mul_f32 v9, v41, v48
    v_fma_f32 v8, v42, v49, v8
    v_fma_f32 v9, v43, v49, v9
    v_fma_f32 v8, v44, v50, v8
    v_fma_f32 v9, v45, v50, v9
    v_fma_f32 v8, v46, v51, v8
    v_fma_f32 v9, v47, v51, v9
    v_cvt_pk_bf16_f32 v8, v8, v9
    v_mov_b32 v9, v8
    v_mov_b32 v4, v9
    s_nop 1
    v_permlane32_swap_b32 v4, v9
    v_xor_b32 v9, v9, v4
    v_mov_b32 v4, v9
    s_nop 1
    v_permlane16_swap_b32 v4, v9
    v_xor_b32 v9, v9, v4
    v_xor_b32 v9, s54, v9
    v_cndmask_b32 v8, v8, v9, s[40:41]
    s_mov_b64 exec, s[48:49]
    buffer_store_dword v8, v92, s[32:35], s47 offen sc1
    s_mov_b64 exec, -1
    v_mov_b32 v4, 2
    ds_write_b32 v24, v4 offset:96
L_redx_81:
    s_endpgm
L_retry_5:
    s_sub_u32 s62, s62, 1
    s_cbranch_scc0 L_spin_3
    s_mov_b32 s62, 0
    s_branch L_done_4
L_retry_18:
    s_sub_u32 s62, s62, 1
    s_cbranch_scc0 L_spin_16
    s_mov_b32 s62, 0
    s_branch L_done_17
L_retry_21:
    s_sub_u32 s62, s62, 1
    s_cbranch_scc0 L_spin_19
    s_mov_b32 s62, 0
    s_branch L_done_20
L_retry_28:
    s_sub_u32 s62, s62, 1
    s_cbranch_scc0 L_spin_26
    s_mov_b32 s62, 0
    s_branch L_done_27
L_retry_31:
    s_sub_u32 s62, s62, 1
    s_cbranch_scc0 L_spin_29
    s_mov_b32 s62, 0
    s_branch L_done_30
L_retry_34:
    s_sub_u32 s62, s62, 1
    s_cbranch_scc0 L_spin_32
    s_mov_b32 s62, 0
    s_branch L_done_33
L_notrdy_35:
    v_mfma_f32_16x16x32_bf16 v[156:159], v[144:147], v[144:147], v[156:159]
    v_mfma_f32_16x16x32_bf16 v[160:163], v[144:147], v[48:51], v[160:163]
    v_mfma_f32_16x16x32_bf16 v[164:167], v[144:147], v[36:39], v[164:167]
    v_mfma_f32_16x16x32_bf16 v[156:159], v[148:151], v[148:151], v[156:159]
    v_mfma_f32_16x16x32_bf16 v[160:163], v[148:151], v[52:55], v[160:163]
    v_mfma_f32_16x16x32_bf16 v[164:167], v[148:151], v[36:39], v[164:167]
L_spin_84:
    ds_read_b32 v2, v24 offset:0
    s_waitcnt lgkmcnt(0)
    v_readfirstlane_b32 s61, v2
    s_nop 0
    s_cmp_ge_u32 s61, 5
    s_cbranch_scc0 L_retry_86
L_done_85:
    ds_read_b128 v[204:207], v10 offset:4096
    ds_read_b128 v[208:211], v11 offset:4096
    ds_read_b128 v[212:215], v12 offset:4096
    ds_read_b128 v[216:219], v13 offset:4096
    s_waitcnt lgkmcnt(0)
    s_branch L_next_36
L_notrdy_37:
    v_mfma_f32_16x16x32_bf16 v[156:159], v[212:215], v[212:215], v[156:159]
    v_mfma_f32_16x16x32_bf16 v[160:163], v[212:215], v[64:67], v[160:163]
    v_mfma_f32_16x16x32_bf16 v[164:167], v[212:215], v[36:39], v[164:167]
    v_mfma_f32_16x16x32_bf16 v[156:159], v[216:219], v[216:219], v[156:159]
    v_mfma_f32_16x16x32_bf16 v[160:163], v[216:219], v[68:71], v[160:163]
    v_mfma_f32_16x16x32_bf16 v[164:167], v[216:219], v[36:39], v[164:167]
L_spin_87:
    ds_read_b32 v2, v24 offset:0
    s_waitcnt lgkmcnt(0)
    v_readfirstlane_b32 s61, v2
    s_nop 0
    s_cmp_ge_u32 s61, 6
    s_cbranch_scc0 L_retry_89
L_done_88:
    ds_read_b128 v[136:139], v10 offset:8192
    ds_read_b128 v[140:143], v11 offset:8192
    ds_read_b128 v[144:147], v12 offset:8192
    ds_read_b128 v[148:151], v13 offset:8192
    s_waitcnt lgkmcnt(0)
    s_branch L_next_38
L_retry_42:
    s_sub_u32 s62, s62, 1
    s_cbranch_scc0 L_spin_40
    s_mov_b32 s62, 0
    s_branch L_done_41
L_notrdy_43:
    v_mfma_f32_16x16x32_bf16 v[156:159], v[144:147], v[144:147], v[156:159]
    v_mfma_f32_16x16x32_bf16 v[160:163], v[144:147], v[48:51], v[160:163]
    v_mfma_f32_16x16x32_bf16 v[164:167], v[144:147], v[36:39], v[164:167]
    v_mfma_f32_16x16x32_bf16 v[156:159], v[148:151], v[148:151], v[156:159]
    v_mfma_f32_16x16x32_bf16 v[160:163], v[148:151], v[52:55], v[160:163]
    v_mfma_f32_16x16x32_bf16 v[164:167], v[148:151], v[36:39], v[164:167]
L_spin_90:
    ds_read_b32 v2, v24 offset:0
    s_waitcnt lgkmcnt(0)
    v_readfirstlane_b32 s61, v2
    s_nop 0
    s_cmp_ge_u32 s61, 8
    s_cbranch_scc0 L_retry_92
L_done_91:
    ds_read_b128 v[204:207], v10 offset:4096
    ds_read_b128 v[208:211], v11 offset:4096
    ds_read_b128 v[212:215], v12 offset:4096
    ds_read_b128 v[216:219], v13 offset:4096
    s_waitcnt lgkmcnt(0)
    s_branch L_next_44
L_notrdy_45:
    v_mfma_f32_16x16x32_bf16 v[156:159], v[212:215], v[212:215], v[156:159]
    v_mfma_f32_16x16x32_bf16 v[160:163], v[212:215], v[64:67], v[160:163]
    v_mfma_f32_16x16x32_bf16 v[164:167], v[212:215], v[36:39], v[164:167]
    v_mfma_f32_16x16x32_bf16 v[156:159], v[216:219], v[216:219], v[156:159]
    v_mfma_f32_16x16x32_bf16 v[160:163], v[216:219], v[68:71], v[160:163]
    v_mfma_f32_16x16x32_bf16 v[164:167], v[216:219], v[36:39], v[164:167]
L_spin_93:
    ds_read_b32 v2, v24 offset:0
    s_waitcnt lgkmcnt(0)
    v_readfirstlane_b32 s61, v2
    s_nop 0
    s_cmp_ge_u32 s61, 9
    s_cbranch_scc0 L_retry_95
L_done_94:
    ds_read_b128 v[136:139], v10 offset:8192
    ds_read_b128 v[140:143], v11 offset:8192
    ds_read_b128 v[144:147], v12 offset:8192
    ds_read_b128 v[148:151], v13 offset:8192
    s_waitcnt lgkmcnt(0)
    s_branch L_next_46
L_retry_50:
    s_sub_u32 s62, s62, 1
    s_cbranch_scc0 L_spin_48
    s_mov_b32 s62, 0
    s_branch L_done_49
L_xretry_55:
    s_waitcnt lgkmcnt(0)
    s_sub_u32 s62, s62, 1
    s_cbranch_scc0 L_xsp_53
    s_mov_b32 s62, 0
    s_branch L_xok_54
L_retry_58:
    s_sub_u32 s62, s62, 1
    s_cbranch_scc0 L_spin_56
    s_mov_b32 s62, 0
    s_branch L_done_57
L_notrdy_59:
    v_mfma_f32_16x16x32_bf16 v[156:159], v[144:147], v[144:147], v[156:159]
    v_mfma_f32_16x16x32_bf16 v[160:163], v[144:147], v[48:51], v[160:163]
    v_mfma_f32_16x16x32_bf16 v[164:167], v[144:147], v[36:39], v[164:167]
    v_mfma_f32_16x16x32_bf16 v[152:155], v[144:147], v[96:99], v[152:155]
    v_mfma_f32_16x16x32_bf16 v[156:159], v[148:151], v[148:151], v[156:159]
    v_mfma_f32_16x16x32_bf16 v[160:163], v[148:151], v[52:55], v[160:163]
    v_mfma_f32_16x16x32_bf16 v[164:167], v[148:151], v[36:39], v[164:167]
    v_mfma_f32_16x16x32_bf16 v[152:155], v[148:151], v[100:103], v[152:155]
L_spin_96:
    ds_read_b64 v[2:3], v24 offset:240
    s_waitcnt lgkmcnt(0)
    v_min_u32 v2, v2, v3
    s_nop 0
    v_readfirstlane_b32 s61, v2
    s_nop 0
    s_cmp_ge_u32 s61, 2
    s_cbranch_scc0 L_retry_98
L_done_97:
    ds_read_b128 v[204:207], v10 offset:4096
    ds_read_b128 v[208:211], v11 offset:4096
    ds_read_b128 v[212:215], v12 offset:4096
    ds_read_b128 v[216:219], v13 offset:4096
    s_waitcnt lgkmcnt(0)
    s_branch L_next_60
L_notrdy_61:
    v_mfma_f32_16x16x32_bf16 v[156:159], v[212:215], v[212:215], v[156:159]
    v_mfma_f32_16x16x32_bf16 v[160:163], v[212:215], v[64:67], v[160:163]
    v_mfma_f32_16x16x32_bf16 v[164:167], v[212:215], v[36:39], v[164:167]
    v_mfma_f32_16x16x32_bf16 v[152:155], v[212:215], v[112:115], v[152:155]
    v_mfma_f32_16x16x32_bf16 v[156:159], v[216:219], v[216:219], v[156:159]
    v_mfma_f32_16x16x32_bf16 v[160:163], v[216:219], v[68:71], v[160:163]
    v_mfma_f32_16x16x32_bf16 v[164:167], v[216:219], v[36:39], v[164:167]
    v_mfma_f32_16x16x32_bf16 v[152:155], v[216:219], v[116:119], v[152:155]
L_spin_99:
    ds_read_b64 v[2:3], v24 offset:240
    s_waitcnt lgkmcnt(0)
    v_min_u32 v2, v2, v3
    s_nop 0
    v_readfirstlane_b32 s61, v2
    s_nop 0
    s_cmp_ge_u32 s61, 3
    s_cbranch_scc0 L_retry_101
L_done_100:
    ds_read_b128 v[136:139], v10 offset:8192
    ds_read_b128 v[140:143], v11 offset:8192
    ds_read_b128 v[144:147], v12 offset:8192
    ds_read_b128 v[148:151], v13 offset:8192
    s_waitcnt lgkmcnt(0)
    s_branch L_next_62
L_retry_65:
    s_sub_u32 s62, s62, 1
    s_cbranch_scc0 L_spin_63
    s_mov_b32 s62, 0
    s_branch L_done_64
L_notrdy_66:
    v_mfma_f32_16x16x32_bf16 v[156:159], v[144:147], v[144:147], v[156:159]
    v_mfma_f32_16x16x32_bf16 v[160:163], v[144:147], v[48:51], v[160:163]
    v_mfma_f32_16x16x32_bf16 v[164:167], v[144:147], v[36:39], v[164:167]
    v_mfma_f32_16x16x32_bf16 v[152:155], v[144:147], v[96:99], v[152:155]
    v_mfma_f32_16x16x32_bf16 v[156:159], v[148:151], v[148:151], v[156:159]
    v_mfma_f32_16x16x32_bf16 v[160:163], v[148:151], v[52:55], v[160:163]
    v_mfma_f32_16x16x32_bf16 v[164:167], v[148:151], v[36:39], v[164:167]
    v_mfma_f32_16x16x32_bf16 v[152:155], v[148:151], v[100:103], v[152:155]
L_spin_102:
    ds_read_b32 v2, v24 offset:0
    s_waitcnt lgkmcnt(0)
    v_readfirstlane_b32 s61, v2
    s_nop 0
    s_cmp_ge_u32 s61, 11
    s_cbranch_scc0 L_retry_104
L_done_103:
    ds_read_b128 v[204:207], v10 offset:4096
    ds_read_b128 v[208:211], v11 offset:4096
    ds_read_b128 v[212:215], v12 offset:4096
    ds_read_b128 v[216:219], v13 offset:4096
    s_waitcnt lgkmcnt(0)
    s_branch L_next_67
L_notrdy_68:
    v_mfma_f32_16x16x32_bf16 v[156:159], v[212:215], v[212:215], v[156:159]
    v_mfma_f32_16x16x32_bf16 v[160:163], v[212:215], v[64:67], v[160:163]
    v_mfma_f32_16x16x32_bf16 v[164:167], v[212:215], v[36:39], v[164:167]
    v_mfma_f32_16x16x32_bf16 v[152:155], v[212:215], v[112:115], v[152:155]
    v_mfma_f32_16x16x32_bf16 v[156:159], v[216:219], v[216:219], v[156:159]
    v_mfma_f32_16x16x32_bf16 v[160:163], v[216:219], v[68:71], v[160:163]
    v_mfma_f32_16x16x32_bf16 v[164:167], v[216:219], v[36:39], v[164:167]
    v_mfma_f32_16x16x32_bf16 v[152:155], v[216:219], v[116:119], v[152:155]
L_spin_105:
    ds_read_b32 v2, v24 offset:0
    s_waitcnt lgkmcnt(0)
    v_readfirstlane_b32 s61, v2
    s_nop 0
    s_cmp_ge_u32 s61, 12
    s_cbranch_scc0 L_retry_107
L_done_106:
    ds_read_b128 v[136:139], v10 offset:8192
    ds_read_b128 v[140:143], v11 offset:8192
    ds_read_b128 v[144:147], v12 offset:8192
    ds_read_b128 v[148:151], v13 offset:8192
    s_waitcnt lgkmcnt(0)
    s_branch L_next_69
L_xretry_72:
    s_waitcnt lgkmcnt(0)
    s_sub_u32 s62, s62, 1
    s_cbranch_scc0 L_xsp_70
    s_mov_b32 s62, 0
    s_branch L_xok_71
L_slow_73:
    v_max3_f32 v2, v152, v153, v154
    v_max3_f32 v2, v2, v155, v236
    v_max3_f32 v2, v2, v237, v238
    v_max_f32 v2, v2, v239
    v_mov_b32 v3, v2
    s_nop 1
    v_permlane32_swap_b32 v3, v2
    v_max_f32 v2, v2, v3
    v_mov_b32 v3, v2
    s_nop 1
    v_permlane16_swap_b32 v3, v2
    v_max_f32 v2, v2, v3
    ds_write_b32 v22, v2 offset:768
    v_mov_b32 v3, 6
    ds_write_b32 v25, v3 offset:112
L_spin_108:
    ds_read_b128 v[2:5], v24 offset:112
    s_waitcnt lgkmcnt(0)
    v_min3_u32 v2, v2, v3, v4
    v_min_u32 v2, v2, v5
    s_nop 0
    v_readfirstlane_b32 s61, v2
    s_nop 0
    s_cmp_ge_u32 s61, 6
    s_cbranch_scc0 L_retry_110
L_done_109:
    ds_read_b128 v[2:5], v23 offset:768
    s_waitcnt lgkmcnt(0)
    v_max3_f32 v2, v2, v3, v4
    v_max_f32 v2, v2, v5
    v_max_f32 v2, v2, v28
    v_and_b32 v4, 0xffff0000, v2
    v_cmp_gt_f32 vcc, v2, v4
    v_add_u32 v5, 0x10000, v4
    s_nop 0
    v_cndmask_b32 v2, v4, v5, vcc
    v_sub_f32 v3, v28, v2
    v_exp_f32 v3, v3
    v_mov_b32 v28, v2
    v_mul_f32 v180, v180, v3
    v_mul_f32 v181, v181, v3
    v_mul_f32 v182, v182, v3
    v_mul_f32 v183, v183, v3
    v_mul_f32 v184, v184, v3
    v_mul_f32 v185, v185, v3
    v_mul_f32 v186, v186, v3
    v_mul_f32 v187, v187, v3
    v_mul_f32 v188, v188, v3
    v_mul_f32 v189, v189, v3
    v_mul_f32 v190, v190, v3
    v_mul_f32 v191, v191, v3
    v_mul_f32 v192, v192, v3
    v_mul_f32 v193, v193, v3
    v_mul_f32 v194, v194, v3
    v_mul_f32 v195, v195, v3
    v_mul_f32 v196, v196, v3
    v_mul_f32 v197, v197, v3
    v_mul_f32 v198, v198, v3
    v_mul_f32 v199, v199, v3
    v_mul_f32 v200, v200, v3
    v_mul_f32 v201, v201, v3
    v_mul_f32 v202, v202, v3
    v_mul_f32 v203, v203, v3
    v_mul_f32 v29, v29, v3
    v_mul_f32 v32, v32, v3
    v_mul_f32 v33, v33, v3
    v_mul_f32 v34, v34, v3
    v_mul_f32 v35, v35, v3
    v_pk_add_f32 v[212:213], v[236:237], v[28:29] op_sel_hi:[1,0] neg_lo:[0,1] neg_hi:[0,1]
    v_pk_add_f32 v[214:215], v[238:239], v[28:29] op_sel_hi:[1,0] neg_lo:[0,1] neg_hi:[0,1]
    v_pk_add_f32 v[156:157], v[152:153], v[28:29] op_sel_hi:[1,0] neg_lo:[0,1] neg_hi:[0,1]
    v_pk_add_f32 v[158:159], v[154:155], v[28:29] op_sel_hi:[1,0] neg_lo:[0,1] neg_hi:[0,1]
    v_exp_f32 v156, v156
    v_exp_f32 v157, v157
    v_exp_f32 v158, v158
    v_exp_f32 v159, v159
    v_exp_f32 v212, v212
    v_exp_f32 v213, v213
    v_exp_f32 v214, v214
    v_exp_f32 v215, v215
    v_pk_mul_f32 v[164:165], v[156:157], v[160:161]
    v_pk_mul_f32 v[166:167], v[158:159], v[162:163]
    v_pk_mul_f32 v[216:217], v[212:213], v[240:241]
    v_pk_mul_f32 v[218:219], v[214:215], v[242:243]
    v_cvt_pk_bf16_f32 v30, v164, v165
    v_cvt_pk_bf16_f32 v31, v166, v167
    v_cvt_pk_bf16_f32 v8, v216, v217
    v_cvt_pk_bf16_f32 v9, v218, v219
    ds_write_b64 v20, v[30:31] offset:6144
    ds_write_b64 v20, v[8:9] offset:4096
    v_pk_add_f32 v[216:217], v[216:217], v[32:33]
    v_pk_add_f32 v[218:219], v[218:219], v[34:35]
    v_pk_add_f32 v[216:217], v[216:217], v[164:165]
    v_pk_add_f32 v[218:219], v[218:219], v[166:167]
    v_cvt_pk_bf16_f32 v2, v216, v217
    v_cvt_pk_bf16_f32 v3, v218, v219
    ds_write_b64 v20, v[2:3] offset:8192
    v_pk_add_f32 v[212:213], v[212:213], v[156:157]
    v_pk_add_f32 v[214:215], v[214:215], v[158:159]
    v_add_f32 v212, v212, v213
    v_add_f32 v214, v214, v215
    v_add_f32 v212, v212, v214
    v_add_f32 v212, v212, v29
    ds_write_b32 v27, v212
    v_mov_b32 v2, 7
    ds_write_b32 v25, v2 offset:112
L_spin_111:
    ds_read_b128 v[2:5], v24 offset:112
    s_waitcnt lgkmcnt(0)
    v_min3_u32 v2, v2, v3, v4
    v_min_u32 v2, v2, v5
    s_nop 0
    v_readfirstlane_b32 s61, v2
    s_nop 0
    s_cmp_ge_u32 s61, 7
    s_cbranch_scc0 L_retry_113
L_done_112:
    ds_read2st64_b64 v[136:139], v21 offset0:8 offset1:9
    ds_read2st64_b64 v[140:143], v21 offset0:10 offset1:11
    ds_read2st64_b64 v[144:147], v21 offset0:12 offset1:13
    ds_read2st64_b64 v[148:151], v21 offset0:14 offset1:15
    ds_read2st64_b64 v[204:207], v21 offset0:16 offset1:17
    ds_read2st64_b64 v[208:211], v21 offset0:18 offset1:19
    s_waitcnt lgkmcnt(0)
    s_branch L_go_74
L_retry_78:
    s_sub_u32 s62, s62, 1
    s_cbranch_scc0 L_spin_76
    s_mov_b32 s62, 0
    s_branch L_done_77
L_retry_86:
    s_sub_u32 s62, s62, 1
    s_cbranch_scc0 L_spin_84
    s_mov_b32 s62, 0
    s_branch L_done_85
L_retry_89:
    s_sub_u32 s62, s62, 1
    s_cbranch_scc0 L_spin_87
    s_mov_b32 s62, 0
    s_branch L_done_88
L_retry_92:
    s_sub_u32 s62, s62, 1
    s_cbranch_scc0 L_spin_90
    s_mov_b32 s62, 0
    s_branch L_done_91
L_retry_95:
    s_sub_u32 s62, s62, 1
    s_cbranch_scc0 L_spin_93
    s_mov_b32 s62, 0
    s_branch L_done_94
L_retry_98:
    s_sub_u32 s62, s62, 1
    s_cbranch_scc0 L_spin_96
    s_mov_b32 s62, 0
    s_branch L_done_97
L_retry_101:
    s_sub_u32 s62, s62, 1
    s_cbranch_scc0 L_spin_99
    s_mov_b32 s62, 0
    s_branch L_done_100
L_retry_104:
    s_sub_u32 s62, s62, 1
    s_cbranch_scc0 L_spin_102
    s_mov_b32 s62, 0
    s_branch L_done_103
L_retry_107:
    s_sub_u32 s62, s62, 1
    s_cbranch_scc0 L_spin_105
    s_mov_b32 s62, 0
    s_branch L_done_106
L_retry_110:
    s_sub_u32 s62, s62, 1
    s_cbranch_scc0 L_spin_108
    s_mov_b32 s62, 0
    s_branch L_done_109
L_retry_113:
    s_sub_u32 s62, s62, 1
    s_cbranch_scc0 L_spin_111
    s_mov_b32 s62, 0
    s_branch L_done_112
L_main_poller:
    s_waitcnt lgkmcnt(0)
    s_load_dword s54, s[22:23], 0
    s_mov_b32 s24, s6
    s_and_b32 s25, s7, 0xffff
    s_mov_b32 s26, 50331648
    s_mov_b32 s27, 0x20000
    s_mov_b32 s28, s8
    s_and_b32 s29, s9, 0xffff
    s_mov_b32 s30, 12582912
    s_mov_b32 s31, 0x20000
    s_mov_b32 s32, s22
    s_and_b32 s33, s23, 0xffff
    s_mov_b32 s34, 268435456
    s_mov_b32 s35, 0x20000
    v_mov_b32 v15, 159744
    v_lshlrev_b32 v2, 4, v0
    v_lshlrev_b32 v3, 2, v0
    s_waitcnt lgkmcnt(0)
    s_add_u32 s54, s54, 1
    s_and_b32 s61, s54, 0xffff
    s_cmp_eq_u32 s61, 0
    s_addc_u32 s54, s54, 0
    s_cmp_ge_u32 s2, 6
    s_cbranch_scc1 L_slpn_114
    s_sleep 127
    s_sleep 38
    s_branch L_slpd_115
L_slpn_114:
    s_sleep 127
    s_sleep 78
L_slpd_115:
L_spin_116:
    ds_read_b128 v[8:11], v15 offset:64
    s_waitcnt lgkmcnt(0)
    v_min3_u32 v8, v8, v9, v10
    v_min_u32 v8, v8, v11
    s_nop 0
    v_readfirstlane_b32 s61, v8
    s_nop 0
    s_cmp_ge_u32 s61, 1
    s_cbranch_scc0 L_retry_118
L_done_117:
    v_mov_b32 v80, 0x3f803f80
    v_mov_b32 v81, 0x3f803f80
    v_mov_b32 v82, 0x3f803f80
    v_mov_b32 v83, 0x3f803f80
    v_and_b32 v12, 15, v0
    v_lshlrev_b32 v12, 2, v12
    v_add_u32 v12, 160064, v12
    v_add_u32 v13, 147456, v2
L_pimg_119:
    s_mov_b32 s44, 20480
    buffer_load_dwordx4 v[16:19], v2, s[32:35], s44 offen offset:0 sc1
    buffer_load_dwordx4 v[20:23], v2, s[32:35], s44 offen offset:1024 sc1
    buffer_load_dwordx4 v[24:27], v2, s[32:35], s44 offen offset:2048 sc1
    buffer_load_dwordx4 v[28:31], v2, s[32:35], s44 offen offset:3072 sc1
    s_add_u32 s44, s44, 4096
    buffer_load_dwordx4 v[32:35], v2, s[32:35], s44 offen offset:0 sc1
    buffer_load_dwordx4 v[36:39], v2, s[32:35], s44 offen offset:1024 sc1
    buffer_load_dwordx4 v[40:43], v2, s[32:35], s44 offen offset:2048 sc1
    buffer_load_dwordx4 v[44:47], v2, s[32:35], s44 offen offset:3072 sc1
    s_add_u32 s44, s44, 4096
    buffer_load_dwordx4 v[48:51], v2, s[32:35], s44 offen offset:0 sc1
    buffer_load_dwordx4 v[52:55], v2, s[32:35], s44 offen offset:1024 sc1
    buffer_load_dwordx4 v[56:59], v2, s[32:35], s44 offen offset:2048 sc1
    buffer_load_dwordx4 v[60:63], v2, s[32:35], s44 offen offset:3072 sc1
    s_mov_b32 s44, 32768
    buffer_load_dword v64, v3, s[32:35], s44 offen offset:0 sc1
    buffer_load_dword v65, v3, s[32:35], s44 offen offset:256 sc1
    buffer_load_dword v66, v3, s[32:35], s44 offen offset:512 sc1
    buffer_load_dword v67, v3, s[32:35], s44 offen offset:768 sc1
    buffer_load_dword v68, v3, s[32:35], s44 offen offset:1024 sc1
    buffer_load_dword v69, v3, s[32:35], s44 offen offset:1280 sc1
    buffer_load_dword v70, v3, s[32:35], s44 offen offset:1536 sc1
    buffer_load_dword v71, v3, s[32:35], s44 offen offset:1792 sc1
    buffer_load_dword v72, v3, s[32:35], s44 offen offset:2048 sc1
    buffer_load_dword v73, v3, s[32:35], s44 offen offset:2304 sc1
    buffer_load_dword v74, v3, s[32:35], s44 offen offset:2560 sc1
    buffer_load_dword v75, v3, s[32:35], s44 offen offset:2816 sc1
    s_waitcnt vmcnt(23)
    v_bitop3_b32 v4, v16, v17, v18 bitop3:0x96
    s_waitcnt vmcnt(11)
    v_bitop3_b32 v4, v4, v19, v64 bitop3:0x96
    v_xor_b32 v5, s54, v4
    v_bitop3_b32 v4, v20, v21, v22 bitop3:0x96
    s_waitcnt vmcnt(10)
    v_bitop3_b32 v4, v4, v23, v65 bitop3:0x96
    v_bitop3_b32 v5, v4, v5, s54 bitop3:0xde
    v_bitop3_b32 v4, v24, v25, v26 bitop3:0x96
    s_waitcnt vmcnt(9)
    v_bitop3_b32 v4, v4, v27, v66 bitop3:0x96
    v_bitop3_b32 v5, v4, v5, s54 bitop3:0xde
    v_bitop3_b32 v4, v28, v29, v30 bitop3:0x96
    s_waitcnt vmcnt(8)
    v_bitop3_b32 v4, v4, v31, v67 bitop3:0x96
    v_bitop3_b32 v5, v4, v5, s54 bitop3:0xde
    v_bitop3_b32 v4, v32, v33, v34 bitop3:0x96
    s_waitcnt vmcnt(7)
    v_bitop3_b32 v4, v4, v35, v68 bitop3:0x96
    v_bitop3_b32 v5, v4, v5, s54 bitop3:0xde
    v_bitop3_b32 v4, v36, v37, v38 bitop3:0x96
    s_waitcnt vmcnt(6)
    v_bitop3_b32 v4, v4, v39, v69 bitop3:0x96
    v_bitop3_b32 v5, v4, v5, s54 bitop3:0xde
    v_bitop3_b32 v4, v40, v41, v42 bitop3:0x96
    s_waitcnt vmcnt(5)
    v_bitop3_b32 v4, v4, v43, v70 bitop3:0x96
    v_bitop3_b32 v5, v4, v5, s54 bitop3:0xde
    v_bitop3_b32 v4, v44, v45, v46 bitop3:0x96
    s_waitcnt vmcnt(4)
    v_bitop3_b32 v4, v4, v47, v71 bitop3:0x96
    v_bitop3_b32 v5, v4, v5, s54 bitop3:0xde
    v_bitop3_b32 v4, v48, v49, v50 bitop3:0x96
    s_waitcnt vmcnt(3)
    v_bitop3_b32 v4, v4, v51, v72 bitop3:0x96
    v_bitop3_b32 v5, v4, v5, s54 bitop3:0xde
    v_bitop3_b32 v4, v52, v53, v54 bitop3:0x96
    s_waitcnt vmcnt(2)
    v_bitop3_b32 v4, v4, v55, v73 bitop3:0x96
    v_bitop3_b32 v5, v4, v5, s54 bitop3:0xde
    v_bitop3_b32 v4, v56, v57, v58 bitop3:0x96
    s_waitcnt vmcnt(1)
    v_bitop3_b32 v4, v4, v59, v74 bitop3:0x96
    v_bitop3_b32 v5, v4, v5, s54 bitop3:0xde
    v_bitop3_b32 v4, v60, v61, v62 bitop3:0x96
    s_waitcnt vmcnt(0)
    v_bitop3_b32 v4, v4, v63, v75 bitop3:0x96
    v_bitop3_b32 v5, v4, v5, s54 bitop3:0xde
    v_cmp_ne_u32 vcc, 0, v5
    s_nop 0
    s_cbranch_vccz L_pimgd_120
    s_sub_u32 s55, s55, 1
    s_cbranch_scc0 L_pimg_119
    s_mov_b32 s55, 0
L_pimgd_120:
    v_mfma_f32_16x16x32_bf16 v[84:87], v[80:83], v[16:19], 0
    ds_write_b128 v13, v[16:19] offset:0
    v_mfma_f32_16x16x32_bf16 v[84:87], v[80:83], v[20:23], v[84:87]
    ds_write_b128 v13, v[20:23] offset:1024
    v_mfma_f32_16x16x32_bf16 v[84:87], v[80:83], v[24:27], v[84:87]
    ds_write_b128 v13, v[24:27] offset:2048
    v_mfma_f32_16x16x32_bf16 v[84:87], v[80:83], v[28:31], v[84:87]
    ds_write_b128 v13, v[28:31] offset:3072
    v_mfma_f32_16x16x32_bf16 v[84:87], v[80:83], v[32:35], v[84:87]
    ds_write_b128 v13, v[32:35] offset:4096
    v_mfma_f32_16x16x32_bf16 v[84:87], v[80:83], v[36:39], v[84:87]
    ds_write_b128 v13, v[36:39] offset:5120
    v_mfma_f32_16x16x32_bf16 v[84:87], v[80:83], v[40:43], v[84:87]
    ds_write_b128 v13, v[40:43] offset:6144
    v_mfma_f32_16x16x32_bf16 v[84:87], v[80:83], v[44:47], v[84:87]
    ds_write_b128 v13, v[44:47] offset:7168
    v_mfma_f32_16x16x32_bf16 v[84:87], v[80:83], v[48:51], v[84:87]
    ds_write_b128 v13, v[48:51] offset:8192
    v_mfma_f32_16x16x32_bf16 v[84:87], v[80:83], v[52:55], v[84:87]
    ds_write_b128 v13, v[52:55] offset:9216
    v_mfma_f32_16x16x32_bf16 v[84:87], v[80:83], v[56:59], v[84:87]
    ds_write_b128 v13, v[56:59] offset:10240
    v_mfma_f32_16x16x32_bf16 v[84:87], v[80:83], v[60:63], v[84:87]
    ds_write_b128 v13, v[60:63] offset:11264
    s_nop 6
    ds_write_b32 v12, v84
    v_mov_b32 v6, 1
    ds_write_b32 v15, v6 offset:4
    s_sleep 127
    s_sleep 33
    v_mov_b32 v6, 1
    ds_write_b32 v15, v6 offset:304
    s_cmp_lt_u32 s2, 176
    s_cbranch_scc1 L_nolsum_121
    s_cmp_ge_u32 s2, 180
    s_cbranch_scc1 L_nolsum_121
    s_sub_u32 s40, s2, 176
    s_lshl_b32 s41, s40, 14
    s_add_u32 s41, s41, 524288
    s_add_u32 s42, s41, 4096
    s_add_u32 s43, s41, 8192
    s_add_u32 s45, s41, 12288
    v_lshlrev_b32 v2, 4, v0
L_pgr_122:
    buffer_load_dwordx4 v[16:19], v2, s[32:35], s41 offen offset:0 sc1
    buffer_load_dwordx4 v[20:23], v2, s[32:35], s41 offen offset:1024 sc1
    buffer_load_dwordx4 v[24:27], v2, s[32:35], s41 offen offset:2048 sc1
    buffer_load_dwordx4 v[28:31], v2, s[32:35], s41 offen offset:3072 sc1
    buffer_load_dwordx4 v[32:35], v2, s[32:35], s42 offen offset:0 sc1
    buffer_load_dwordx4 v[36:39], v2, s[32:35], s42 offen offset:1024 sc1
    buffer_load_dwordx4 v[40:43], v2, s[32:35], s42 offen offset:2048 sc1
    buffer_load_dwordx4 v[44:47], v2, s[32:35], s42 offen offset:3072 sc1
    buffer_load_dwordx4 v[48:51], v2, s[32:35], s43 offen offset:0 sc1
    buffer_load_dwordx4 v[52:55], v2, s[32:35], s43 offen offset:1024 sc1
    buffer_load_dwordx4 v[56:59], v2, s[32:35], s43 offen offset:2048 sc1
    buffer_load_dwordx4 v[60:63], v2, s[32:35], s43 offen offset:3072 sc1
    buffer_load_dwordx4 v[64:67], v2, s[32:35], s45 offen offset:0 sc1
    buffer_load_dwordx4 v[68:71], v2, s[32:35], s45 offen offset:1024 sc1
    buffer_load_dwordx4 v[72:75], v2, s[32:35], s45 offen offset:2048 sc1
    buffer_load_dwordx4 v[76:79], v2, s[32:35], s45 offen offset:3072 sc1
    s_waitcnt vmcnt(15)
    v_bitop3_b32 v4, v16, v17, v18 bitop3:0x96
    v_xor_b32 v4, v4, v19
    v_xor_b32 v5, s54, v4
    s_waitcnt vmcnt(14)
    v_bitop3_b32 v4, v20, v21, v22 bitop3:0x96
    v_xor_b32 v4, v4, v23
    v_bitop3_b32 v5, v4, v5, s54 bitop3:0xde
    s_waitcnt vmcnt(13)
    v_bitop3_b32 v4, v24, v25, v26 bitop3:0x96
    v_xor_b32 v4, v4, v27
    v_bitop3_b32 v5, v4, v5, s54 bitop3:0xde
    s_waitcnt vmcnt(12)
    v_bitop3_b32 v4, v28, v29, v30 bitop3:0x96
    v_xor_b32 v4, v4, v31
    v_bitop3_b32 v5, v4, v5, s54 bitop3:0xde
    s_waitcnt vmcnt(11)
    v_bitop3_b32 v4, v32, v33, v34 bitop3:0x96
    v_xor_b32 v4, v4, v35
    v_bitop3_b32 v5, v4, v5, s54 bitop3:0xde
    s_waitcnt vmcnt(10)
    v_bitop3_b32 v4, v36, v37, v38 bitop3:0x96
    v_xor_b32 v4, v4, v39
    v_bitop3_b32 v5, v4, v5, s54 bitop3:0xde
    s_waitcnt vmcnt(9)
    v_bitop3_b32 v4, v40, v41, v42 bitop3:0x96
    v_xor_b32 v4, v4, v43
    v_bitop3_b32 v5, v4, v5, s54 bitop3:0xde
    s_waitcnt vmcnt(8)
    v_bitop3_b32 v4, v44, v45, v46 bitop3:0x96
    v_xor_b32 v4, v4, v47
    v_bitop3_b32 v5, v4, v5, s54 bitop3:0xde
    s_waitcnt vmcnt(7)
    v_bitop3_b32 v4, v48, v49, v50 bitop3:0x96
    v_xor_b32 v4, v4, v51
    v_bitop3_b32 v5, v4, v5, s54 bitop3:0xde
    s_waitcnt vmcnt(6)
    v_bitop3_b32 v4, v52, v53, v54 bitop3:0x96
    v_xor_b32 v4, v4, v55
    v_bitop3_b32 v5, v4, v5, s54 bitop3:0xde
    s_waitcnt vmcnt(5)
    v_bitop3_b32 v4, v56, v57, v58 bitop3:0x96
    v_xor_b32 v4, v4, v59
    v_bitop3_b32 v5, v4, v5, s54 bitop3:0xde
    s_waitcnt vmcnt(4)
    v_bitop3_b32 v4, v60, v61, v62 bitop3:0x96
    v_xor_b32 v4, v4, v63
    v_bitop3_b32 v5, v4, v5, s54 bitop3:0xde
    s_waitcnt vmcnt(3)
    v_bitop3_b32 v4, v64, v65, v66 bitop3:0x96
    v_xor_b32 v4, v4, v67
    v_bitop3_b32 v5, v4, v5, s54 bitop3:0xde
    s_waitcnt vmcnt(2)
    v_bitop3_b32 v4, v68, v69, v70 bitop3:0x96
    v_xor_b32 v4, v4, v71
    v_bitop3_b32 v5, v4, v5, s54 bitop3:0xde
    s_waitcnt vmcnt(1)
    v_bitop3_b32 v4, v72, v73, v74 bitop3:0x96
    v_xor_b32 v4, v4, v75
    v_bitop3_b32 v5, v4, v5, s54 bitop3:0xde
    s_waitcnt vmcnt(0)
    v_bitop3_b32 v4, v76, v77, v78 bitop3:0x96
    v_xor_b32 v4, v4, v79
    v_bitop3_b32 v5, v4, v5, s54 bitop3:0xde
    v_cmp_ne_u32 vcc, 0, v5
    s_nop 0
    s_and_b64 exec, exec, vcc
    s_cbranch_execz L_pgrd_123
    s_sub_u32 s55, s55, 1
    s_cbranch_scc0 L_pgr_122
    s_mov_b32 s55, 0
L_pgrd_123:
    s_mov_b64 exec, -1
    v_max3_f32 v6, v16, v20, v24
    v_max3_f32 v6, v6, v28, v32
    v_max3_f32 v6, v6, v36, v40
    v_max3_f32 v6, v6, v44, v48
    v_max3_f32 v6, v6, v52, v56
    v_max3_f32 v6, v6, v60, v64
    v_max3_f32 v6, v6, v68, v72
    v_max_f32 v6, v6, v76
    s_nop 1
    v_max_f32_dpp v6, v6, v6 row_ror:4 row_mask:0xf bank_mask:0xf
    s_nop 1
    v_max_f32_dpp v6, v6, v6 row_ror:8 row_mask:0xf bank_mask:0xf
    v_mov_b32 v7, v6
    s_nop 1
    v_permlane32_swap_b32 v7, v6
    v_max_f32 v6, v6, v7
    v_mov_b32 v7, v6
    s_nop 1
    v_permlane16_swap_b32 v7, v6
    v_max_f32 v6, v6, v7
    v_sub_f32 v16, v16, v6
    v_sub_f32 v20, v20, v6
    v_sub_f32 v24, v24, v6
    v_sub_f32 v28, v28, v6
    v_sub_f32 v32, v32, v6
    v_sub_f32 v36, v36, v6
    v_sub_f32 v40, v40, v6
    v_sub_f32 v44, v44, v6
    v_sub_f32 v48, v48, v6
    v_sub_f32 v52, v52, v6
    v_sub_f32 v56, v56, v6
    v_sub_f32 v60, v60, v6
    v_sub_f32 v64, v64, v6
    v_sub_f32 v68, v68, v6
    v_sub_f32 v72, v72, v6
    v_sub_f32 v76, v76, v6
    v_exp_f32 v16, v16
    v_exp_f32 v20, v20
    v_exp_f32 v24, v24
    v_exp_f32 v28, v28
    v_exp_f32 v32, v32
    v_exp_f32 v36, v36
    v_exp_f32 v40, v40
    v_exp_f32 v44, v44
    v_exp_f32 v48, v48
    v_exp_f32 v52, v52
    v_exp_f32 v56, v56
    v_exp_f32 v60, v60
    v_exp_f32 v64, v64
    v_exp_f32 v68, v68
    v_exp_f32 v72, v72
    v_exp_f32 v76, v76
    v_mul_f32 v8, v16, v17
    v_fma_f32 v8, v20, v21, v8
    v_fma_f32 v8, v24, v25, v8
    v_fma_f32 v8, v28, v29, v8
    v_fma_f32 v8, v32, v33, v8
    v_fma_f32 v8, v36, v37, v8
    v_fma_f32 v8, v40, v41, v8
    v_fma_f32 v8, v44, v45, v8
    v_fma_f32 v8, v48, v49, v8
    v_fma_f32 v8, v52, v53, v8
    v_fma_f32 v8, v56, v57, v8
    v_fma_f32 v8, v60, v61, v8
    v_fma_f32 v8, v64, v65, v8
    v_fma_f32 v8, v68, v69, v8
    v_fma_f32 v8, v72, v73, v8
    v_fma_f32 v8, v76, v77, v8
    s_nop 1
    v_add_f32_dpp v8, v8, v8 row_ror:4 row_mask:0xf bank_mask:0xf
    s_nop 1
    v_add_f32_dpp v8, v8, v8 row_ror:8 row_mask:0xf bank_mask:0xf
    v_mov_b32 v7, v8
    s_nop 1
    v_permlane32_swap_b32 v7, v8
    v_add_f32 v8, v8, v7
    v_mov_b32 v7, v8
    s_nop 1
    v_permlane16_swap_b32 v7, v8
    v_add_f32 v8, v8, v7
    v_mov_b32 v9, v6
    v_mov_b32 v10, 0
    v_bitop3_b32 v11, v8, v9, v10 bitop3:0x96
    v_xor_b32 v11, s54, v11
    s_lshl_b32 s41, s40, 6
    s_add_u32 s41, s41, 491520
    s_mov_b64 exec, 0xf
    buffer_store_dwordx4 v[8:11], v2, s[32:35], s41 offen sc1
    s_mov_b64 exec, -1
L_nolsum_121:
    s_endpgm
L_retry_118:
    s_sub_u32 s62, s62, 1
    s_cbranch_scc0 L_spin_116
    s_mov_b32 s62, 0
    s_branch L_done_117
L_main_spill:
    s_waitcnt lgkmcnt(0)
    s_load_dword s54, s[22:23], 0
    s_mov_b32 s24, s6
    s_and_b32 s25, s7, 0xffff
    s_mov_b32 s26, 50331648
    s_mov_b32 s27, 0x20000
    s_mov_b32 s28, s8
    s_and_b32 s29, s9, 0xffff
    s_mov_b32 s30, 12582912
    s_mov_b32 s31, 0x20000
    s_mov_b32 s32, s22
    s_and_b32 s33, s23, 0xffff
    s_mov_b32 s34, 268435456
    s_mov_b32 s35, 0x20000
    s_cmp_eq_u32 s3, 6
    s_cbranch_scc1 L_s1_124
    s_lshr_b32 s42, s2, 3
    s_and_b32 s43, s2, 7
    s_mul_i32 s40, s42, 393216
    s_mul_i32 s44, s43, 24576
    s_add_u32 s40, s40, s44
    s_mul_i32 s41, s42, 98304
    s_mul_i32 s44, s43, 12288
    s_add_u32 s41, s41, s44
    v_lshrrev_b32 v1, 4, v0
    v_and_b32 v2, 15, v0
    v_add_u32 v3, 0, v1
    v_lshlrev_b32 v4, 1, v3
    v_xor_b32 v4, v4, v2
    v_and_b32 v4, 15, v4
    v_lshlrev_b32 v4, 4, v4
    v_mul_u32_u24 v5, 768, v3
    v_add_u32 v10, v5, v4
    v_mul_u32_u24 v5, 1536, v3
    v_add_u32 v12, v5, v4
    v_add_u32 v3, 4, v1
    v_lshlrev_b32 v4, 1, v3
    v_xor_b32 v4, v4, v2
    v_and_b32 v4, 15, v4
    v_lshlrev_b32 v4, 4, v4
    v_mul_u32_u24 v5, 768, v3
    v_add_u32 v11, v5, v4
    v_mul_u32_u24 v5, 1536, v3
    v_add_u32 v13, v5, v4
    v_mov_b32 v15, 159744
    v_lshlrev_b32 v14, 4, v0
    v_add_u32 v14, 49152, v14
L_spin_126:
    ds_read_b32 v2, v15 offset:0
    s_waitcnt lgkmcnt(0)
    v_readfirstlane_b32 s61, v2
    s_nop 0
    s_cmp_ge_u32 s61, 3
    s_cbranch_scc0 L_retry_128
L_done_127:
    v_lshlrev_b32 v9, 4, v0
    v_add_u32 v8, 98304, v9
    v_add_u32 v9, 0, v9
    ds_read_b128 v[112:115], v9 offset:0
    ds_read_b128 v[116:119], v9 offset:1024
    ds_read_b128 v[120:123], v9 offset:2048
    ds_read_b128 v[124:127], v9 offset:3072
    ds_read_b128 v[128:131], v9 offset:4096
    ds_read_b128 v[132:135], v9 offset:5120
    ds_read_b128 v[136:139], v9 offset:6144
    ds_read_b128 v[140:143], v9 offset:7168
    ds_read_b128 v[144:147], v9 offset:8192
    ds_read_b128 v[148:151], v9 offset:9216
    ds_read_b128 v[152:155], v9 offset:10240
    ds_read_b128 v[156:159], v9 offset:11264
    ds_read_b128 v[160:163], v9 offset:12288
    ds_read_b128 v[164:167], v9 offset:13312
    ds_read_b128 v[168:171], v9 offset:14336
    ds_read_b128 v[172:175], v9 offset:15360
    ds_read_b128 v[176:179], v9 offset:16384
    ds_read_b128 v[180:183], v9 offset:17408
    ds_read_b128 v[184:187], v9 offset:18432
    ds_read_b128 v[188:191], v9 offset:19456
    ds_read_b128 v[192:195], v9 offset:20480
    ds_read_b128 v[196:199], v9 offset:21504
    ds_read_b128 v[200:203], v9 offset:22528
    ds_read_b128 v[204:207], v9 offset:23552
    v_mov_b32 v6, 1
    ds_write_b32 v15, v6 offset:272
    s_waitcnt lgkmcnt(0)
L_spin_129:
    ds_read_b32 v2, v15 offset:12
    s_waitcnt lgkmcnt(0)
    v_readfirstlane_b32 s61, v2
    s_nop 0
    s_cmp_ge_u32 s61, 1
    s_cbranch_scc0 L_retry_131
L_done_130:
    s_add_u32 s44, s40, 196608
    buffer_load_dwordx4 v[16:19], v12, s[24:27], s44 offen nt
    s_add_u32 s44, s40, 196608
    buffer_load_dwordx4 v[20:23], v13, s[24:27], s44 offen nt
    s_add_u32 s44, s40, 208896
    buffer_load_dwordx4 v[24:27], v12, s[24:27], s44 offen nt
    s_add_u32 s44, s40, 208896
    buffer_load_dwordx4 v[28:31], v13, s[24:27], s44 offen nt
    s_add_u32 s44, s40, 12779520
    buffer_load_dwordx4 v[32:35], v12, s[24:27], s44 offen nt
    s_add_u32 s44, s40, 12779520
    buffer_load_dwordx4 v[36:39], v13, s[24:27], s44 offen nt
    s_add_u32 s44, s40, 12791808
    buffer_load_dwordx4 v[40:43], v12, s[24:27], s44 offen nt
    s_add_u32 s44, s40, 12791808
    buffer_load_dwordx4 v[44:47], v13, s[24:27], s44 offen nt
    s_add_u32 s44, s40, 196864
    buffer_load_dwordx4 v[48:51], v12, s[24:27], s44 offen nt
    s_add_u32 s44, s40, 196864
    buffer_load_dwordx4 v[52:55], v13, s[24:27], s44 offen nt
    s_add_u32 s44, s40, 209152
    buffer_load_dwordx4 v[56:59], v12, s[24:27], s44 offen nt
    s_waitcnt vmcnt(10)
    s_add_u32 s44, s40, 209152
    buffer_load_dwordx4 v[60:63], v13, s[24:27], s44 offen nt
    s_waitcnt vmcnt(10)
    s_add_u32 s44, s40, 12779776
    buffer_load_dwordx4 v[64:67], v12, s[24:27], s44 offen nt
    s_waitcnt vmcnt(10)
    s_add_u32 s44, s40, 12779776
    buffer_load_dwordx4 v[68:71], v13, s[24:27], s44 offen nt
    s_waitcnt vmcnt(10)
    s_add_u32 s44, s40, 12792064
    buffer_load_dwordx4 v[72:75], v12, s[24:27], s44 offen nt
    s_waitcnt vmcnt(10)
    s_add_u32 s44, s40, 12792064
    buffer_load_dwordx4 v[76:79], v13, s[24:27], s44 offen nt
    s_waitcnt vmcnt(10)
    s_add_u32 s44, s40, 197120
    buffer_load_dwordx4 v[80:83], v12, s[24:27], s44 offen nt
    s_waitcnt vmcnt(10)
    s_add_u32 s44, s40, 197120
    buffer_load_dwordx4 v[84:87], v13, s[24:27], s44 offen nt
    s_waitcnt vmcnt(10)
    s_add_u32 s44, s40, 209408
    buffer_load_dwordx4 v[88:91], v12, s[24:27], s44 offen nt
    s_waitcnt vmcnt(10)
    s_add_u32 s44, s40, 209408
    buffer_load_dwordx4 v[92:95], v13, s[24:27], s44 offen nt
    s_waitcnt vmcnt(10)
    s_add_u32 s44, s40, 12780032
    buffer_load_dwordx4 v[96:99], v12, s[24:27], s44 offen nt
    s_waitcnt vmcnt(10)
    s_add_u32 s44, s40, 12780032
    buffer_load_dwordx4 v[100:103], v13, s[24:27], s44 offen nt
    s_waitcnt vmcnt(10)
    s_add_u32 s44, s40, 12792320
    buffer_load_dwordx4 v[104:107], v12, s[24:27], s44 offen nt
    s_waitcnt vmcnt(10)
    s_add_u32 s44, s40, 12792320
    buffer_load_dwordx4 v[108:111], v13, s[24:27], s44 offen nt
    v_mov_b32 v6, 1
    ds_write_b32 v15, v6 offset:248
    s_waitcnt vmcnt(16)
L_spink_132:
    ds_read_b128 v[2:5], v15 offset:32
    s_waitcnt lgkmcnt(0)
    v_min3_u32 v2, v2, v3, v4
    v_min_u32 v2, v2, v5
    s_nop 0
    v_readfirstlane_b32 s61, v2
    s_nop 0
    s_cmp_ge_u32 s61, 1
    s_cbranch_scc1 L_donek_133
    s_sub_u32 s62, s62, 1
    s_cbranch_scc0 L_spink_132
    s_mov_b32 s62, 0
L_donek_133:
    s_waitcnt vmcnt(16)
    ds_write_b128 v14, v[16:19] offset:0
    ds_write_b128 v14, v[20:23] offset:1024
    ds_write_b128 v14, v[24:27] offset:2048
    ds_write_b128 v14, v[28:31] offset:3072
    ds_write_b128 v14, v[32:35] offset:12288
    ds_write_b128 v14, v[36:39] offset:13312
    ds_write_b128 v14, v[40:43] offset:14336
    ds_write_b128 v14, v[44:47] offset:15360
    v_mov_b32 v6, 1
    ds_write_b32 v15, v6 offset:240
    s_waitcnt vmcnt(8)
    ds_write_b128 v14, v[48:51] offset:4096
    ds_write_b128 v14, v[52:55] offset:5120
    ds_write_b128 v14, v[56:59] offset:6144
    ds_write_b128 v14, v[60:63] offset:7168
    ds_write_b128 v14, v[64:67] offset:16384
    ds_write_b128 v14, v[68:71] offset:17408
    ds_write_b128 v14, v[72:75] offset:18432
    ds_write_b128 v14, v[76:79] offset:19456
    v_mov_b32 v6, 2
    ds_write_b32 v15, v6 offset:240
    s_waitcnt vmcnt(0)
    ds_write_b128 v14, v[80:83] offset:8192
    ds_write_b128 v14, v[84:87] offset:9216
    ds_write_b128 v14, v[88:91] offset:10240
    ds_write_b128 v14, v[92:95] offset:11264
    ds_write_b128 v14, v[96:99] offset:20480
    ds_write_b128 v14, v[100:103] offset:21504
    ds_write_b128 v14, v[104:107] offset:22528
    ds_write_b128 v14, v[108:111] offset:23552
    v_mov_b32 v6, 3
    ds_write_b32 v15, v6 offset:240
L_spin_134:
    ds_read_b128 v[2:5], v15 offset:256
    s_waitcnt lgkmcnt(0)
    v_min3_u32 v2, v2, v3, v4
    v_min_u32 v2, v2, v5
    s_nop 0
    v_readfirstlane_b32 s61, v2
    s_nop 0
    s_cmp_ge_u32 s61, 1
    s_cbranch_scc0 L_retry_136
L_done_135:
    ds_write_b128 v8, v[112:115] offset:0
    ds_write_b128 v8, v[116:119] offset:1024
    ds_write_b128 v8, v[120:123] offset:2048
    ds_write_b128 v8, v[124:127] offset:3072
    ds_write_b128 v8, v[128:131] offset:4096
    ds_write_b128 v8, v[132:135] offset:5120
    ds_write_b128 v8, v[136:139] offset:6144
    ds_write_b128 v8, v[140:143] offset:7168
    ds_write_b128 v8, v[144:147] offset:8192
    ds_write_b128 v8, v[148:151] offset:9216
    ds_write_b128 v8, v[152:155] offset:10240
    ds_write_b128 v8, v[156:159] offset:11264
    ds_write_b128 v8, v[160:163] offset:12288
    ds_write_b128 v8, v[164:167] offset:13312
    ds_write_b128 v8, v[168:171] offset:14336
    ds_write_b128 v8, v[172:175] offset:15360
    ds_write_b128 v8, v[176:179] offset:16384
    ds_write_b128 v8, v[180:183] offset:17408
    ds_write_b128 v8, v[184:187] offset:18432
    ds_write_b128 v8, v[188:191] offset:19456
    ds_write_b128 v8, v[192:195] offset:20480
    ds_write_b128 v8, v[196:199] offset:21504
    ds_write_b128 v8, v[200:203] offset:22528
    ds_write_b128 v8, v[204:207] offset:23552
    v_mov_b32 v6, 1
    ds_write_b32 v15, v6 offset:280
    s_branch L_sdone_125
L_s1_124:
    s_lshr_b32 s42, s2, 3
    s_and_b32 s43, s2, 7
    s_mul_i32 s40, s42, 393216
    s_mul_i32 s44, s43, 24576
    s_add_u32 s40, s40, s44
    s_mul_i32 s41, s42, 98304
    s_mul_i32 s44, s43, 12288
    s_add_u32 s41, s41, s44
    v_lshrrev_b32 v1, 4, v0
    v_and_b32 v2, 15, v0
    v_add_u32 v3, 0, v1
    v_lshlrev_b32 v4, 1, v3
    v_xor_b32 v4, v4, v2
    v_and_b32 v4, 15, v4
    v_lshlrev_b32 v4, 4, v4
    v_mul_u32_u24 v5, 768, v3
    v_add_u32 v10, v5, v4
    v_mul_u32_u24 v5, 1536, v3
    v_add_u32 v12, v5, v4
    v_add_u32 v3, 4, v1
    v_lshlrev_b32 v4, 1, v3
    v_xor_b32 v4, v4, v2
    v_and_b32 v4, 15, v4
    v_lshlrev_b32 v4, 4, v4
    v_mul_u32_u24 v5, 768, v3
    v_add_u32 v11, v5, v4
    v_mul_u32_u24 v5, 1536, v3
    v_add_u32 v13, v5, v4
    v_mov_b32 v15, 159744
    v_lshlrev_b32 v14, 4, v0
    v_add_u32 v14, 49152, v14
L_spin_137:
    ds_read_b32 v2, v15 offset:0
    s_waitcnt lgkmcnt(0)
    v_readfirstlane_b32 s61, v2
    s_nop 0
    s_cmp_ge_u32 s61, 3
    s_cbranch_scc0 L_retry_139
L_done_138:
    v_lshlrev_b32 v9, 4, v0
    v_add_u32 v8, 122880, v9
    v_add_u32 v9, 24576, v9
    ds_read_b128 v[112:115], v9 offset:0
    ds_read_b128 v[116:119], v9 offset:1024
    ds_read_b128 v[120:123], v9 offset:2048
    ds_read_b128 v[124:127], v9 offset:3072
    ds_read_b128 v[128:131], v9 offset:4096
    ds_read_b128 v[132:135], v9 offset:5120
    ds_read_b128 v[136:139], v9 offset:6144
    ds_read_b128 v[140:143], v9 offset:7168
    ds_read_b128 v[144:147], v9 offset:8192
    ds_read_b128 v[148:151], v9 offset:9216
    ds_read_b128 v[152:155], v9 offset:10240
    ds_read_b128 v[156:159], v9 offset:11264
    ds_read_b128 v[160:163], v9 offset:12288
    ds_read_b128 v[164:167], v9 offset:13312
    ds_read_b128 v[168:171], v9 offset:14336
    ds_read_b128 v[172:175], v9 offset:15360
    ds_read_b128 v[176:179], v9 offset:16384
    ds_read_b128 v[180:183], v9 offset:17408
    ds_read_b128 v[184:187], v9 offset:18432
    ds_read_b128 v[188:191], v9 offset:19456
    ds_read_b128 v[192:195], v9 offset:20480
    ds_read_b128 v[196:199], v9 offset:21504
    ds_read_b128 v[200:203], v9 offset:22528
    ds_read_b128 v[204:207], v9 offset:23552
    v_mov_b32 v6, 1
    ds_write_b32 v15, v6 offset:276
    s_waitcnt lgkmcnt(0)
L_spin_140:
    ds_read_b32 v2, v15 offset:12
    s_waitcnt lgkmcnt(0)
    v_readfirstlane_b32 s61, v2
    s_nop 0
    s_cmp_ge_u32 s61, 1
    s_cbranch_scc0 L_retry_142
L_done_141:
    s_add_u32 s44, s40, 25362432
    buffer_load_dwordx4 v[16:19], v12, s[24:27], s44 offen nt
    s_add_u32 s44, s40, 25362432
    buffer_load_dwordx4 v[20:23], v13, s[24:27], s44 offen nt
    s_add_u32 s44, s40, 25374720
    buffer_load_dwordx4 v[24:27], v12, s[24:27], s44 offen nt
    s_add_u32 s44, s40, 25374720
    buffer_load_dwordx4 v[28:31], v13, s[24:27], s44 offen nt
    s_add_u32 s44, s40, 37945344
    buffer_load_dwordx4 v[32:35], v12, s[24:27], s44 offen nt
    s_add_u32 s44, s40, 37945344
    buffer_load_dwordx4 v[36:39], v13, s[24:27], s44 offen nt
    s_add_u32 s44, s40, 37957632
    buffer_load_dwordx4 v[40:43], v12, s[24:27], s44 offen nt
    s_add_u32 s44, s40, 37957632
    buffer_load_dwordx4 v[44:47], v13, s[24:27], s44 offen nt
    s_add_u32 s44, s40, 25362688
    buffer_load_dwordx4 v[48:51], v12, s[24:27], s44 offen nt
    s_add_u32 s44, s40, 25362688
    buffer_load_dwordx4 v[52:55], v13, s[24:27], s44 offen nt
    s_add_u32 s44, s40, 25374976
    buffer_load_dwordx4 v[56:59], v12, s[24:27], s44 offen nt
    s_waitcnt vmcnt(10)
    s_add_u32 s44, s40, 25374976
    buffer_load_dwordx4 v[60:63], v13, s[24:27], s44 offen nt
    s_waitcnt vmcnt(10)
    s_add_u32 s44, s40, 37945600
    buffer_load_dwordx4 v[64:67], v12, s[24:27], s44 offen nt
    s_waitcnt vmcnt(10)
    s_add_u32 s44, s40, 37945600
    buffer_load_dwordx4 v[68:71], v13, s[24:27], s44 offen nt
    s_waitcnt vmcnt(10)
    s_add_u32 s44, s40, 37957888
    buffer_load_dwordx4 v[72:75], v12, s[24:27], s44 offen nt
    s_waitcnt vmcnt(10)
    s_add_u32 s44, s40, 37957888
    buffer_load_dwordx4 v[76:79], v13, s[24:27], s44 offen nt
    s_waitcnt vmcnt(10)
    s_add_u32 s44, s40, 25362944
    buffer_load_dwordx4 v[80:83], v12, s[24:27], s44 offen nt
    s_waitcnt vmcnt(10)
    s_add_u32 s44, s40, 25362944
    buffer_load_dwordx4 v[84:87], v13, s[24:27], s44 offen nt
    s_waitcnt vmcnt(10)
    s_add_u32 s44, s40, 25375232
    buffer_load_dwordx4 v[88:91], v12, s[24:27], s44 offen nt
    s_waitcnt vmcnt(10)
    s_add_u32 s44, s40, 25375232
    buffer_load_dwordx4 v[92:95], v13, s[24:27], s44 offen nt
    s_waitcnt vmcnt(10)
    s_add_u32 s44, s40, 37945856
    buffer_load_dwordx4 v[96:99], v12, s[24:27], s44 offen nt
    s_waitcnt vmcnt(10)
    s_add_u32 s44, s40, 37945856
    buffer_load_dwordx4 v[100:103], v13, s[24:27], s44 offen nt
    s_waitcnt vmcnt(10)
    s_add_u32 s44, s40, 37958144
    buffer_load_dwordx4 v[104:107], v12, s[24:27], s44 offen nt
    s_waitcnt vmcnt(10)
    s_add_u32 s44, s40, 37958144
    buffer_load_dwordx4 v[108:111], v13, s[24:27], s44 offen nt
    v_mov_b32 v6, 1
    ds_write_b32 v15, v6 offset:252
    s_waitcnt vmcnt(16)
L_spink_143:
    ds_read_b128 v[2:5], v15 offset:32
    s_waitcnt lgkmcnt(0)
    v_min3_u32 v2, v2, v3, v4
    v_min_u32 v2, v2, v5
    s_nop 0
    v_readfirstlane_b32 s61, v2
    s_nop 0
    s_cmp_ge_u32 s61, 1
    s_cbranch_scc1 L_donek_144
    s_sub_u32 s62, s62, 1
    s_cbranch_scc0 L_spink_143
    s_mov_b32 s62, 0
L_donek_144:
    s_waitcnt vmcnt(16)
    ds_write_b128 v14, v[16:19] offset:24576
    ds_write_b128 v14, v[20:23] offset:25600
    ds_write_b128 v14, v[24:27] offset:26624
    ds_write_b128 v14, v[28:31] offset:27648
    ds_write_b128 v14, v[32:35] offset:36864
    ds_write_b128 v14, v[36:39] offset:37888
    ds_write_b128 v14, v[40:43] offset:38912
    ds_write_b128 v14, v[44:47] offset:39936
    v_mov_b32 v6, 1
    ds_write_b32 v15, v6 offset:244
    s_waitcnt vmcnt(8)
    ds_write_b128 v14, v[48:51] offset:28672
    ds_write_b128 v14, v[52:55] offset:29696
    ds_write_b128 v14, v[56:59] offset:30720
    ds_write_b128 v14, v[60:63] offset:31744
    ds_write_b128 v14, v[64:67] offset:40960
    ds_write_b128 v14, v[68:71] offset:41984
    ds_write_b128 v14, v[72:75] offset:43008
    ds_write_b128 v14, v[76:79] offset:44032
    v_mov_b32 v6, 2
    ds_write_b32 v15, v6 offset:244
    s_waitcnt vmcnt(0)
    ds_write_b128 v14, v[80:83] offset:32768
    ds_write_b128 v14, v[84:87] offset:33792
    ds_write_b128 v14, v[88:91] offset:34816
    ds_write_b128 v14, v[92:95] offset:35840
    ds_write_b128 v14, v[96:99] offset:45056
    ds_write_b128 v14, v[100:103] offset:46080
    ds_write_b128 v14, v[104:107] offset:47104
    ds_write_b128 v14, v[108:111] offset:48128
    v_mov_b32 v6, 3
    ds_write_b32 v15, v6 offset:244
L_spin_145:
    ds_read_b128 v[2:5], v15 offset:256
    s_waitcnt lgkmcnt(0)
    v_min3_u32 v2, v2, v3, v4
    v_min_u32 v2, v2, v5
    s_nop 0
    v_readfirstlane_b32 s61, v2
    s_nop 0
    s_cmp_ge_u32 s61, 1
    s_cbranch_scc0 L_retry_147
L_done_146:
    ds_write_b128 v8, v[112:115] offset:0
    ds_write_b128 v8, v[116:119] offset:1024
    ds_write_b128 v8, v[120:123] offset:2048
    ds_write_b128 v8, v[124:127] offset:3072
    ds_write_b128 v8, v[128:131] offset:4096
    ds_write_b128 v8, v[132:135] offset:5120
    ds_write_b128 v8, v[136:139] offset:6144
    ds_write_b128 v8, v[140:143] offset:7168
    ds_write_b128 v8, v[144:147] offset:8192
    ds_write_b128 v8, v[148:151] offset:9216
    ds_write_b128 v8, v[152:155] offset:10240
    ds_write_b128 v8, v[156:159] offset:11264
    ds_write_b128 v8, v[160:163] offset:12288
    ds_write_b128 v8, v[164:167] offset:13312
    ds_write_b128 v8, v[168:171] offset:14336
    ds_write_b128 v8, v[172:175] offset:15360
    ds_write_b128 v8, v[176:179] offset:16384
    ds_write_b128 v8, v[180:183] offset:17408
    ds_write_b128 v8, v[184:187] offset:18432
    ds_write_b128 v8, v[188:191] offset:19456
    ds_write_b128 v8, v[192:195] offset:20480
    ds_write_b128 v8, v[196:199] offset:21504
    ds_write_b128 v8, v[200:203] offset:22528
    ds_write_b128 v8, v[204:207] offset:23552
    v_mov_b32 v6, 1
    ds_write_b32 v15, v6 offset:284
L_sdone_125:
    s_endpgm
L_retry_128:
    s_sub_u32 s62, s62, 1
    s_cbranch_scc0 L_spin_126
    s_mov_b32 s62, 0
    s_branch L_done_127
L_retry_131:
    s_sub_u32 s62, s62, 1
    s_cbranch_scc0 L_spin_129
    s_mov_b32 s62, 0
    s_branch L_done_130
L_retry_136:
    s_sub_u32 s62, s62, 1
    s_cbranch_scc0 L_spin_134
    s_mov_b32 s62, 0
    s_branch L_done_135
L_retry_139:
    s_sub_u32 s62, s62, 1
    s_cbranch_scc0 L_spin_137
    s_mov_b32 s62, 0
    s_branch L_done_138
L_retry_142:
    s_sub_u32 s62, s62, 1
    s_cbranch_scc0 L_spin_140
    s_mov_b32 s62, 0
    s_branch L_done_141
L_retry_147:
    s_sub_u32 s62, s62, 1
    s_cbranch_scc0 L_spin_145
    s_mov_b32 s62, 0
    s_branch L_done_146
L_main_loader:
    s_cmp_ge_u32 s2, 6
    s_cbranch_scc1 L_nr_151
    s_branch L_ldhold_148
L_nr_151:
    s_cmp_lt_u32 s2, 32
    s_cbranch_scc1 L_nr_152
    s_cmp_ge_u32 s2, 176
    s_cbranch_scc1 L_nr_152
    s_branch L_ldrole_149
L_nr_152:
    s_waitcnt vmcnt(17)
    s_mov_b32 m0, 6144
    s_add_u32 s44, s41, 6400
    buffer_load_dwordx4 v10, s[28:31], s44 offen nt lds
    s_waitcnt vmcnt(17)
    s_mov_b32 m0, 7168
    s_add_u32 s44, s41, 6400
    buffer_load_dwordx4 v11, s[28:31], s44 offen nt lds
    s_waitcnt vmcnt(17)
    s_mov_b32 m0, 16384
    s_add_u32 s44, s41, 3145984
    buffer_load_dwordx4 v10, s[28:31], s44 offen nt lds
    s_waitcnt vmcnt(17)
    s_mov_b32 m0, 17408
    s_add_u32 s44, s41, 3145984
    buffer_load_dwordx4 v11, s[28:31], s44 offen nt lds
    s_waitcnt vmcnt(17)
    s_mov_b32 m0, 18432
    s_add_u32 s44, s41, 3152128
    buffer_load_dwordx4 v10, s[28:31], s44 offen nt lds
    s_waitcnt vmcnt(17)
    s_mov_b32 m0, 19456
    s_add_u32 s44, s41, 3152128
    buffer_load_dwordx4 v11, s[28:31], s44 offen nt lds
    s_waitcnt vmcnt(17)
    s_mov_b32 m0, 28672
    s_add_u32 s44, s41, 6291712
    buffer_load_dwordx4 v10, s[28:31], s44 offen nt lds
    s_waitcnt vmcnt(17)
    s_mov_b32 m0, 29696
    s_add_u32 s44, s41, 6291712
    buffer_load_dwordx4 v11, s[28:31], s44 offen nt lds
    s_waitcnt vmcnt(17)
    s_mov_b32 m0, 30720
    s_add_u32 s44, s41, 6297856
    buffer_load_dwordx4 v10, s[28:31], s44 offen nt lds
    s_waitcnt vmcnt(17)
    s_mov_b32 m0, 31744
    s_add_u32 s44, s41, 6297856
    buffer_load_dwordx4 v11, s[28:31], s44 offen nt lds
    s_waitcnt vmcnt(17)
    s_mov_b32 m0, 40960
    s_add_u32 s44, s41, 9437440
    buffer_load_dwordx4 v10, s[28:31], s44 offen nt lds
    s_waitcnt vmcnt(17)
    s_mov_b32 m0, 41984
    s_add_u32 s44, s41, 9437440
    buffer_load_dwordx4 v11, s[28:31], s44 offen nt lds
    s_waitcnt vmcnt(17)
    s_mov_b32 m0, 43008
    s_add_u32 s44, s41, 9443584
    buffer_load_dwordx4 v10, s[28:31], s44 offen nt lds
    s_waitcnt vmcnt(17)
    s_mov_b32 m0, 44032
    s_add_u32 s44, s41, 9443584
    buffer_load_dwordx4 v11, s[28:31], s44 offen nt lds
    s_waitcnt vmcnt(17)
    s_mov_b32 m0, 8192
    s_add_u32 s44, s41, 512
    buffer_load_dwordx4 v10, s[28:31], s44 offen nt lds
    s_waitcnt vmcnt(17)
    v_mov_b32 v6, 1
    ds_write_b32 v15, v6 offset:0
    s_mov_b32 m0, 9216
    s_add_u32 s44, s41, 512
    buffer_load_dwordx4 v11, s[28:31], s44 offen nt lds
    s_waitcnt vmcnt(17)
    s_mov_b32 m0, 10240
    s_add_u32 s44, s41, 6656
    buffer_load_dwordx4 v10, s[28:31], s44 offen nt lds
    s_waitcnt vmcnt(17)
    s_mov_b32 m0, 11264
    s_add_u32 s44, s41, 6656
    buffer_load_dwordx4 v11, s[28:31], s44 offen nt lds
    s_waitcnt vmcnt(17)
    s_mov_b32 m0, 20480
    s_add_u32 s44, s41, 3146240
    buffer_load_dwordx4 v10, s[28:31], s44 offen nt lds
    s_waitcnt vmcnt(17)
    s_mov_b32 m0, 21504
    s_add_u32 s44, s41, 3146240
    buffer_load_dwordx4 v11, s[28:31], s44 offen nt lds
    s_waitcnt vmcnt(17)
    s_mov_b32 m0, 22528
    s_add_u32 s44, s41, 3152384
    buffer_load_dwordx4 v10, s[28:31], s44 offen nt lds
    s_waitcnt vmcnt(17)
    s_mov_b32 m0, 23552
    s_add_u32 s44, s41, 3152384
    buffer_load_dwordx4 v11, s[28:31], s44 offen nt lds
    s_waitcnt vmcnt(17)
    s_mov_b32 m0, 32768
    s_add_u32 s44, s41, 6291968
    buffer_load_dwordx4 v10, s[28:31], s44 offen nt lds
    s_waitcnt vmcnt(17)
    s_mov_b32 m0, 33792
    s_add_u32 s44, s41, 6291968
    buffer_load_dwordx4 v11, s[28:31], s44 offen nt lds
    s_waitcnt vmcnt(17)
    s_mov_b32 m0, 34816
    s_add_u32 s44, s41, 6298112
    buffer_load_dwordx4 v10, s[28:31], s44 offen nt lds
    s_waitcnt vmcnt(17)
    s_mov_b32 m0, 35840
    s_add_u32 s44, s41, 6298112
    buffer_load_dwordx4 v11, s[28:31], s44 offen nt lds
    s_waitcnt vmcnt(17)
    s_mov_b32 m0, 45056
    s_add_u32 s44, s41, 9437696
    buffer_load_dwordx4 v10, s[28:31], s44 offen nt lds
    s_waitcnt vmcnt(17)
    s_mov_b32 m0, 46080
    s_add_u32 s44, s41, 9437696
    buffer_load_dwordx4 v11, s[28:31], s44 offen nt lds
    s_waitcnt vmcnt(17)
    s_mov_b32 m0, 47104
    s_add_u32 s44, s41, 9443840
    buffer_load_dwordx4 v10, s[28:31], s44 offen nt lds
    s_waitcnt vmcnt(17)
    s_mov_b32 m0, 48128
    s_add_u32 s44, s41, 9443840
    buffer_load_dwordx4 v11, s[28:31], s44 offen nt lds
    s_waitcnt vmcnt(17)
    s_mov_b32 m0, 49152
    s_add_u32 s44, s40, 0
    buffer_load_dwordx4 v12, s[24:27], s44 offen nt lds
    s_waitcnt vmcnt(17)
    v_mov_b32 v6, 2
    ds_write_b32 v15, v6 offset:0
    s_mov_b32 m0, 50176
    s_add_u32 s44, s40, 0
    buffer_load_dwordx4 v13, s[24:27], s44 offen nt lds
    s_waitcnt vmcnt(17)
    s_mov_b32 m0, 51200
    s_add_u32 s44, s40, 12288
    buffer_load_dwordx4 v12, s[24:27], s44 offen nt lds
    s_waitcnt vmcnt(17)
    s_mov_b32 m0, 52224
    s_add_u32 s44, s40, 12288
    buffer_load_dwordx4 v13, s[24:27], s44 offen nt lds
    s_waitcnt vmcnt(17)
    s_mov_b32 m0, 61440
    s_add_u32 s44, s40, 12582912
    buffer_load_dwordx4 v12, s[24:27], s44 offen nt lds
    s_waitcnt vmcnt(17)
    s_mov_b32 m0, 62464
    s_add_u32 s44, s40, 12582912
    buffer_load_dwordx4 v13, s[24:27], s44 offen nt lds
    s_waitcnt vmcnt(17)
    s_mov_b32 m0, 63488
    s_add_u32 s44, s40, 12595200
    buffer_load_dwordx4 v12, s[24:27], s44 offen nt lds
    s_waitcnt vmcnt(17)
    s_mov_b32 m0, 64512
    s_add_u32 s44, s40, 12595200
    buffer_load_dwordx4 v13, s[24:27], s44 offen nt lds
    s_waitcnt vmcnt(17)
    s_mov_b32 m0, 73728
    s_add_u32 s44, s40, 25165824
    buffer_load_dwordx4 v12, s[24:27], s44 offen nt lds
    s_waitcnt vmcnt(17)
    s_mov_b32 m0, 74752
    s_add_u32 s44, s40, 25165824
    buffer_load_dwordx4 v13, s[24:27], s44 offen nt lds
    s_waitcnt vmcnt(17)
    s_mov_b32 m0, 75776
    s_add_u32 s44, s40, 25178112
    buffer_load_dwordx4 v12, s[24:27], s44 offen nt lds
    s_waitcnt vmcnt(17)
    s_mov_b32 m0, 76800
    s_add_u32 s44, s40, 25178112
    buffer_load_dwordx4 v13, s[24:27], s44 offen nt lds
    s_waitcnt vmcnt(17)
    s_mov_b32 m0, 86016
    s_add_u32 s44, s40, 37748736
    buffer_load_dwordx4 v12, s[24:27], s44 offen nt lds
    s_waitcnt vmcnt(17)
    s_mov_b32 m0, 87040
    s_add_u32 s44, s40, 37748736
    buffer_load_dwordx4 v13, s[24:27], s44 offen nt lds
    s_waitcnt vmcnt(17)
    s_mov_b32 m0, 88064
    s_add_u32 s44, s40, 37761024
    buffer_load_dwordx4 v12, s[24:27], s44 offen nt lds
    s_waitcnt vmcnt(17)
    s_mov_b32 m0, 89088
    s_add_u32 s44, s40, 37761024
    buffer_load_dwordx4 v13, s[24:27], s44 offen nt lds
    s_waitcnt vmcnt(17)
    s_mov_b32 m0, 53248
    s_add_u32 s44, s40, 256
    buffer_load_dwordx4 v12, s[24:27], s44 offen nt lds
    s_waitcnt vmcnt(17)
    v_mov_b32 v6, 3
    ds_write_b32 v15, v6 offset:0
    s_mov_b32 m0, 54272
    s_add_u32 s44, s40, 256
    buffer_load_dwordx4 v13, s[24:27], s44 offen nt lds
    s_waitcnt vmcnt(17)
    s_mov_b32 m0, 55296
    s_add_u32 s44, s40, 12544
    buffer_load_dwordx4 v12, s[24:27], s44 offen nt lds
    s_waitcnt vmcnt(17)
    s_mov_b32 m0, 56320
    s_add_u32 s44, s40, 12544
    buffer_load_dwordx4 v13, s[24:27], s44 offen nt lds
    s_waitcnt vmcnt(17)
    s_mov_b32 m0, 65536
    s_add_u32 s44, s40, 12583168
    buffer_load_dwordx4 v12, s[24:27], s44 offen nt lds
    s_waitcnt vmcnt(17)
    s_mov_b32 m0, 66560
    s_add_u32 s44, s40, 12583168
    buffer_load_dwordx4 v13, s[24:27], s44 offen nt lds
    s_waitcnt vmcnt(17)
    s_mov_b32 m0, 67584
    s_add_u32 s44, s40, 12595456
    buffer_load_dwordx4 v12, s[24:27], s44 offen nt lds
    s_waitcnt vmcnt(17)
    s_mov_b32 m0, 68608
    s_add_u32 s44, s40, 12595456
    buffer_load_dwordx4 v13, s[24:27], s44 offen nt lds
    s_waitcnt vmcnt(17)
    s_mov_b32 m0, 77824
    s_add_u32 s44, s40, 25166080
    buffer_load_dwordx4 v12, s[24:27], s44 offen nt lds
    s_waitcnt vmcnt(17)
    s_mov_b32 m0, 78848
    s_add_u32 s44, s40, 25166080
    buffer_load_dwordx4 v13, s[24:27], s44 offen nt lds
    s_waitcnt vmcnt(17)
    s_mov_b32 m0, 79872
    s_add_u32 s44, s40, 25178368
    buffer_load_dwordx4 v12, s[24:27], s44 offen nt lds
    s_waitcnt vmcnt(17)
    s_mov_b32 m0, 80896
    s_add_u32 s44, s40, 25178368
    buffer_load_dwordx4 v13, s[24:27], s44 offen nt lds
    s_waitcnt vmcnt(17)
    s_mov_b32 m0, 90112
    s_add_u32 s44, s40, 37748992
    buffer_load_dwordx4 v12, s[24:27], s44 offen nt lds
    s_waitcnt vmcnt(17)
    s_mov_b32 m0, 91136
    s_add_u32 s44, s40, 37748992
    buffer_load_dwordx4 v13, s[24:27], s44 offen nt lds
    s_waitcnt vmcnt(17)
    s_mov_b32 m0, 92160
    s_add_u32 s44, s40, 37761280
    buffer_load_dwordx4 v12, s[24:27], s44 offen nt lds
    s_waitcnt vmcnt(17)
    s_mov_b32 m0, 93184
    s_add_u32 s44, s40, 37761280
    buffer_load_dwordx4 v13, s[24:27], s44 offen nt lds
    s_waitcnt vmcnt(17)
    s_mov_b32 m0, 57344
    s_add_u32 s44, s40, 512
    buffer_load_dwordx4 v12, s[24:27], s44 offen nt lds
    s_waitcnt vmcnt(17)
    v_mov_b32 v6, 4
    ds_write_b32 v15, v6 offset:0
    s_mov_b32 m0, 58368
    s_add_u32 s44, s40, 512
    buffer_load_dwordx4 v13, s[24:27], s44 offen nt lds
    s_waitcnt vmcnt(17)
    s_mov_b32 m0, 59392
    s_add_u32 s44, s40, 12800
    buffer_load_dwordx4 v12, s[24:27], s44 offen nt lds
    s_waitcnt vmcnt(17)
    s_mov_b32 m0, 60416
    s_add_u32 s44, s40, 12800
    buffer_load_dwordx4 v13, s[24:27], s44 offen nt lds
    s_waitcnt vmcnt(17)
    s_mov_b32 m0, 69632
    s_add_u32 s44, s40, 12583424
    buffer_load_dwordx4 v12, s[24:27], s44 offen nt lds
    s_waitcnt vmcnt(17)
    s_mov_b32 m0, 70656
    s_add_u32 s44, s40, 12583424
    buffer_load_dwordx4 v13, s[24:27], s44 offen nt lds
    s_waitcnt vmcnt(17)
    s_mov_b32 m0, 71680
    s_add_u32 s44, s40, 12595712
    buffer_load_dwordx4 v12, s[24:27], s44 offen nt lds
    s_waitcnt vmcnt(17)
    s_mov_b32 m0, 72704
    s_add_u32 s44, s40, 12595712
    buffer_load_dwordx4 v13, s[24:27], s44 offen nt lds
    s_waitcnt vmcnt(17)
    s_mov_b32 m0, 81920
    s_add_u32 s44, s40, 25166336
    buffer_load_dwordx4 v12, s[24:27], s44 offen nt lds
    s_waitcnt vmcnt(17)
    s_mov_b32 m0, 82944
    s_add_u32 s44, s40, 25166336
    buffer_load_dwordx4 v13, s[24:27], s44 offen nt lds
    s_waitcnt vmcnt(17)
    s_mov_b32 m0, 83968
    s_add_u32 s44, s40, 25178624
    buffer_load_dwordx4 v12, s[24:27], s44 offen nt lds
    s_waitcnt vmcnt(17)
    s_mov_b32 m0, 84992
    s_add_u32 s44, s40, 25178624
    buffer_load_dwordx4 v13, s[24:27], s44 offen nt lds
    s_waitcnt vmcnt(17)
    s_mov_b32 m0, 94208
    s_add_u32 s44, s40, 37749248
    buffer_load_dwordx4 v12, s[24:27], s44 offen nt lds
    s_waitcnt vmcnt(17)
    s_mov_b32 m0, 95232
    s_add_u32 s44, s40, 37749248
    buffer_load_dwordx4 v13, s[24:27], s44 offen nt lds
    s_waitcnt vmcnt(17)
    s_mov_b32 m0, 96256
    s_add_u32 s44, s40, 37761536
    buffer_load_dwordx4 v12, s[24:27], s44 offen nt lds
    s_waitcnt vmcnt(17)
    s_mov_b32 m0, 97280
    s_add_u32 s44, s40, 37761536
    buffer_load_dwordx4 v13, s[24:27], s44 offen nt lds
L_spin_153:
    ds_read_b128 v[16:19], v15 offset:64
    s_waitcnt lgkmcnt(0)
    v_min3_u32 v16, v16, v17, v18
    v_min_u32 v16, v16, v19
    s_nop 0
    v_readfirstlane_b32 s61, v16
    s_nop 0
    s_cmp_ge_u32 s61, 1
    s_cbranch_scc0 L_retry_155
L_done_154:
    s_waitcnt vmcnt(17)
    s_mov_b32 m0, 98304
    s_add_u32 s44, s40, 768
    buffer_load_dwordx4 v12, s[24:27], s44 offen nt lds
    s_waitcnt vmcnt(17)
    v_mov_b32 v6, 5
    ds_write_b32 v15, v6 offset:0
    s_mov_b32 m0, 99328
    s_add_u32 s44, s40, 768
    buffer_load_dwordx4 v13, s[24:27], s44 offen nt lds
    s_waitcnt vmcnt(17)
    s_mov_b32 m0, 100352
    s_add_u32 s44, s40, 13056
    buffer_load_dwordx4 v12, s[24:27], s44 offen nt lds
    s_waitcnt vmcnt(17)
    s_mov_b32 m0, 101376
    s_add_u32 s44, s40, 13056
    buffer_load_dwordx4 v13, s[24:27], s44 offen nt lds
    s_waitcnt vmcnt(17)
    s_mov_b32 m0, 110592
    s_add_u32 s44, s40, 12583680
    buffer_load_dwordx4 v12, s[24:27], s44 offen nt lds
    s_waitcnt vmcnt(17)
    s_mov_b32 m0, 111616
    s_add_u32 s44, s40, 12583680
    buffer_load_dwordx4 v13, s[24:27], s44 offen nt lds
    s_waitcnt vmcnt(17)
    s_mov_b32 m0, 112640
    s_add_u32 s44, s40, 12595968
    buffer_load_dwordx4 v12, s[24:27], s44 offen nt lds
    s_waitcnt vmcnt(17)
    s_mov_b32 m0, 113664
    s_add_u32 s44, s40, 12595968
    buffer_load_dwordx4 v13, s[24:27], s44 offen nt lds
    s_waitcnt vmcnt(17)
    s_mov_b32 m0, 122880
    s_add_u32 s44, s40, 25166592
    buffer_load_dwordx4 v12, s[24:27], s44 offen nt lds
    s_waitcnt vmcnt(17)
    s_mov_b32 m0, 123904
    s_add_u32 s44, s40, 25166592
    buffer_load_dwordx4 v13, s[24:27], s44 offen nt lds
    s_waitcnt vmcnt(17)
    s_mov_b32 m0, 124928
    s_add_u32 s44, s40, 25178880
    buffer_load_dwordx4 v12, s[24:27], s44 offen nt lds
    s_waitcnt vmcnt(17)
    s_mov_b32 m0, 125952
    s_add_u32 s44, s40, 25178880
    buffer_load_dwordx4 v13, s[24:27], s44 offen nt lds
    s_waitcnt vmcnt(17)
    s_mov_b32 m0, 135168
    s_add_u32 s44, s40, 37749504
    buffer_load_dwordx4 v12, s[24:27], s44 offen nt lds
    s_waitcnt vmcnt(17)
    s_mov_b32 m0, 136192
    s_add_u32 s44, s40, 37749504
    buffer_load_dwordx4 v13, s[24:27], s44 offen nt lds
    s_waitcnt vmcnt(17)
    s_mov_b32 m0, 137216
    s_add_u32 s44, s40, 37761792
    buffer_load_dwordx4 v12, s[24:27], s44 offen nt lds
    s_waitcnt vmcnt(17)
    s_mov_b32 m0, 138240
    s_add_u32 s44, s40, 37761792
    buffer_load_dwordx4 v13, s[24:27], s44 offen nt lds
    s_waitcnt vmcnt(17)
    s_mov_b32 m0, 102400
    s_add_u32 s44, s40, 1024
    buffer_load_dwordx4 v12, s[24:27], s44 offen nt lds
    s_waitcnt vmcnt(17)
    v_mov_b32 v6, 6
    ds_write_b32 v15, v6 offset:0
    s_mov_b32 m0, 103424
    s_add_u32 s44, s40, 1024
    buffer_load_dwordx4 v13, s[24:27], s44 offen nt lds
    s_waitcnt vmcnt(17)
    s_mov_b32 m0, 104448
    s_add_u32 s44, s40, 13312
    buffer_load_dwordx4 v12, s[24:27], s44 offen nt lds
    s_waitcnt vmcnt(17)
    s_mov_b32 m0, 105472
    s_add_u32 s44, s40, 13312
    buffer_load_dwordx4 v13, s[24:27], s44 offen nt lds
    s_waitcnt vmcnt(17)
    s_mov_b32 m0, 114688
    s_add_u32 s44, s40, 12583936
    buffer_load_dwordx4 v12, s[24:27], s44 offen nt lds
    s_waitcnt vmcnt(17)
    s_mov_b32 m0, 115712
    s_add_u32 s44, s40, 12583936
    buffer_load_dwordx4 v13, s[24:27], s44 offen nt lds
    s_waitcnt vmcnt(17)
    s_mov_b32 m0, 116736
    s_add_u32 s44, s40, 12596224
    buffer_load_dwordx4 v12, s[24:27], s44 offen nt lds
    s_waitcnt vmcnt(17)
    s_mov_b32 m0, 117760
    s_add_u32 s44, s40, 12596224
    buffer_load_dwordx4 v13, s[24:27], s44 offen nt lds
    s_waitcnt vmcnt(17)
    s_mov_b32 m0, 126976
    s_add_u32 s44, s40, 25166848
    buffer_load_dwordx4 v12, s[24:27], s44 offen nt lds
    s_waitcnt vmcnt(17)
    s_mov_b32 m0, 128000
    s_add_u32 s44, s40, 25166848
    buffer_load_dwordx4 v13, s[24:27], s44 offen nt lds
    s_waitcnt vmcnt(17)
    s_mov_b32 m0, 129024
    s_add_u32 s44, s40, 25179136
    buffer_load_dwordx4 v12, s[24:27], s44 offen nt lds
    s_waitcnt vmcnt(17)
    s_mov_b32 m0, 130048
    s_add_u32 s44, s40, 25179136
    buffer_load_dwordx4 v13, s[24:27], s44 offen nt lds
    s_waitcnt vmcnt(17)
    s_mov_b32 m0, 139264
    s_add_u32 s44, s40, 37749760
    buffer_load_dwordx4 v12, s[24:27], s44 offen nt lds
    s_waitcnt vmcnt(17)
    s_mov_b32 m0, 140288
    s_add_u32 s44, s40, 37749760
    buffer_load_dwordx4 v13, s[24:27], s44 offen nt lds
    s_waitcnt vmcnt(17)
    s_mov_b32 m0, 141312
    s_add_u32 s44, s40, 37762048
    buffer_load_dwordx4 v12, s[24:27], s44 offen nt lds
    s_waitcnt vmcnt(17)
    s_mov_b32 m0, 142336
    s_add_u32 s44, s40, 37762048
    buffer_load_dwordx4 v13, s[24:27], s44 offen nt lds
    s_waitcnt vmcnt(17)
    s_mov_b32 m0, 106496
    s_add_u32 s44, s40, 1280
    buffer_load_dwordx4 v12, s[24:27], s44 offen nt lds
    s_waitcnt vmcnt(17)
    v_mov_b32 v6, 7
    ds_write_b32 v15, v6 offset:0
    s_mov_b32 m0, 107520
    s_add_u32 s44, s40, 1280
    buffer_load_dwordx4 v13, s[24:27], s44 offen nt lds
    s_waitcnt vmcnt(17)
    s_mov_b32 m0, 108544
    s_add_u32 s44, s40, 13568
    buffer_load_dwordx4 v12, s[24:27], s44 offen nt lds
    s_waitcnt vmcnt(17)
    s_mov_b32 m0, 109568
    s_add_u32 s44, s40, 13568
    buffer_load_dwordx4 v13, s[24:27], s44 offen nt lds
    s_waitcnt vmcnt(17)
    s_mov_b32 m0, 118784
    s_add_u32 s44, s40, 12584192
    buffer_load_dwordx4 v12, s[24:27], s44 offen nt lds
    s_waitcnt vmcnt(17)
    s_mov_b32 m0, 119808
    s_add_u32 s44, s40, 12584192
    buffer_load_dwordx4 v13, s[24:27], s44 offen nt lds
    s_waitcnt vmcnt(17)
    s_mov_b32 m0, 120832
    s_add_u32 s44, s40, 12596480
    buffer_load_dwordx4 v12, s[24:27], s44 offen nt lds
    s_waitcnt vmcnt(17)
    s_mov_b32 m0, 121856
    s_add_u32 s44, s40, 12596480
    buffer_load_dwordx4 v13, s[24:27], s44 offen nt lds
    s_waitcnt vmcnt(17)
    s_mov_b32 m0, 131072
    s_add_u32 s44, s40, 25167104
    buffer_load_dwordx4 v12, s[24:27], s44 offen nt lds
    s_waitcnt vmcnt(17)
    s_mov_b32 m0, 132096
    s_add_u32 s44, s40, 25167104
    buffer_load_dwordx4 v13, s[24:27], s44 offen nt lds
    s_waitcnt vmcnt(17)
    s_mov_b32 m0, 133120
    s_add_u32 s44, s40, 25179392
    buffer_load_dwordx4 v12, s[24:27], s44 offen nt lds
    s_waitcnt vmcnt(17)
    s_mov_b32 m0, 134144
    s_add_u32 s44, s40, 25179392
    buffer_load_dwordx4 v13, s[24:27], s44 offen nt lds
    s_waitcnt vmcnt(17)
    s_mov_b32 m0, 143360
    s_add_u32 s44, s40, 37750016
    buffer_load_dwordx4 v12, s[24:27], s44 offen nt lds
    s_waitcnt vmcnt(17)
    s_mov_b32 m0, 144384
    s_add_u32 s44, s40, 37750016
    buffer_load_dwordx4 v13, s[24:27], s44 offen nt lds
    s_waitcnt vmcnt(17)
    s_mov_b32 m0, 145408
    s_add_u32 s44, s40, 37762304
    buffer_load_dwordx4 v12, s[24:27], s44 offen nt lds
    s_waitcnt vmcnt(17)
    s_mov_b32 m0, 146432
    s_add_u32 s44, s40, 37762304
    buffer_load_dwordx4 v13, s[24:27], s44 offen nt lds
    v_mov_b32 v6, 1
    ds_write_b32 v15, v6 offset:12
    s_waitcnt vmcnt(16)
    v_mov_b32 v6, 8
    ds_write_b32 v15, v6 offset:0
    s_waitcnt vmcnt(0)
    v_mov_b32 v6, 9
    ds_write_b32 v15, v6 offset:0
L_spin_156:
    ds_read_b64 v[16:17], v15 offset:248
    s_waitcnt lgkmcnt(0)
    v_min_u32 v16, v16, v17
    s_nop 0
    v_readfirstlane_b32 s61, v16
    s_nop 0
    s_cmp_ge_u32 s61, 1
    s_cbranch_scc0 L_retry_158
L_done_157:
L_spin_159:
    ds_read_b128 v[16:19], v15 offset:16
    s_waitcnt lgkmcnt(0)
    v_min3_u32 v16, v16, v17, v18
    v_min_u32 v16, v16, v19
    s_nop 0
    v_readfirstlane_b32 s61, v16
    s_nop 0
    s_cmp_ge_u32 s61, 1
    s_cbranch_scc0 L_retry_161
L_done_160:
L_spin_162:
    ds_read_b64 v[16:17], v15 offset:272
    s_waitcnt lgkmcnt(0)
    v_min_u32 v16, v16, v17
    s_nop 0
    v_readfirstlane_b32 s61, v16
    s_nop 0
    s_cmp_ge_u32 s61, 1
    s_cbranch_scc0 L_retry_164
L_done_163:
    ds_read_b32 v16, v15 offset:4
    s_waitcnt lgkmcnt(0)
    v_readfirstlane_b32 s61, v16
    s_nop 0
    s_cmp_eq_u32 s61, 0
    s_cbranch_scc1 L_shal_165
    s_mov_b32 m0, 0
    s_add_u32 s44, s40, 197376
    buffer_load_dwordx4 v12, s[24:27], s44 offen nt lds
    s_mov_b32 m0, 1024
    s_add_u32 s44, s40, 197376
    buffer_load_dwordx4 v13, s[24:27], s44 offen nt lds
    s_mov_b32 m0, 2048
    s_add_u32 s44, s40, 209664
    buffer_load_dwordx4 v12, s[24:27], s44 offen nt lds
    s_mov_b32 m0, 3072
    s_add_u32 s44, s40, 209664
    buffer_load_dwordx4 v13, s[24:27], s44 offen nt lds
    s_mov_b32 m0, 12288
    s_add_u32 s44, s40, 12780288
    buffer_load_dwordx4 v12, s[24:27], s44 offen nt lds
    s_mov_b32 m0, 13312
    s_add_u32 s44, s40, 12780288
    buffer_load_dwordx4 v13, s[24:27], s44 offen nt lds
    s_mov_b32 m0, 14336
    s_add_u32 s44, s40, 12792576
    buffer_load_dwordx4 v12, s[24:27], s44 offen nt lds
    s_mov_b32 m0, 15360
    s_add_u32 s44, s40, 12792576
    buffer_load_dwordx4 v13, s[24:27], s44 offen nt lds
    s_mov_b32 m0, 24576
    s_add_u32 s44, s40, 25363200
    buffer_load_dwordx4 v12, s[24:27], s44 offen nt lds
    s_mov_b32 m0, 25600
    s_add_u32 s44, s40, 25363200
    buffer_load_dwordx4 v13, s[24:27], s44 offen nt lds
    s_mov_b32 m0, 26624
    s_add_u32 s44, s40, 25375488
    buffer_load_dwordx4 v12, s[24:27], s44 offen nt lds
    s_mov_b32 m0, 27648
    s_add_u32 s44, s40, 25375488
    buffer_load_dwordx4 v13, s[24:27], s44 offen nt lds
    s_mov_b32 m0, 36864
    s_add_u32 s44, s40, 37946112
    buffer_load_dwordx4 v12, s[24:27], s44 offen nt lds
    s_mov_b32 m0, 37888
    s_add_u32 s44, s40, 37946112
    buffer_load_dwordx4 v13, s[24:27], s44 offen nt lds
    s_mov_b32 m0, 38912
    s_add_u32 s44, s40, 37958400
    buffer_load_dwordx4 v12, s[24:27], s44 offen nt lds
    s_mov_b32 m0, 39936
    s_add_u32 s44, s40, 37958400
    buffer_load_dwordx4 v13, s[24:27], s44 offen nt lds
    s_mov_b32 m0, 4096
    s_add_u32 s44, s40, 197632
    buffer_load_dwordx4 v12, s[24:27], s44 offen nt lds
    s_mov_b32 m0, 5120
    s_add_u32 s44, s40, 197632
    buffer_load_dwordx4 v13, s[24:27], s44 offen nt lds
    s_mov_b32 m0, 6144
    s_add_u32 s44, s40, 209920
    buffer_load_dwordx4 v12, s[24:27], s44 offen nt lds
    s_mov_b32 m0, 7168
    s_add_u32 s44, s40, 209920
    buffer_load_dwordx4 v13, s[24:27], s44 offen nt lds
    s_mov_b32 m0, 16384
    s_add_u32 s44, s40, 12780544
    buffer_load_dwordx4 v12, s[24:27], s44 offen nt lds
    s_mov_b32 m0, 17408
    s_add_u32 s44, s40, 12780544
    buffer_load_dwordx4 v13, s[24:27], s44 offen nt lds
    s_mov_b32 m0, 18432
    s_add_u32 s44, s40, 12792832
    buffer_load_dwordx4 v12, s[24:27], s44 offen nt lds
    s_mov_b32 m0, 19456
    s_add_u32 s44, s40, 12792832
    buffer_load_dwordx4 v13, s[24:27], s44 offen nt lds
    s_mov_b32 m0, 28672
    s_add_u32 s44, s40, 25363456
    buffer_load_dwordx4 v12, s[24:27], s44 offen nt lds
    s_mov_b32 m0, 29696
    s_add_u32 s44, s40, 25363456
    buffer_load_dwordx4 v13, s[24:27], s44 offen nt lds
    s_mov_b32 m0, 30720
    s_add_u32 s44, s40, 25375744
    buffer_load_dwordx4 v12, s[24:27], s44 offen nt lds
    s_mov_b32 m0, 31744
    s_add_u32 s44, s40, 25375744
    buffer_load_dwordx4 v13, s[24:27], s44 offen nt lds
    s_mov_b32 m0, 40960
    s_add_u32 s44, s40, 37946368
    buffer_load_dwordx4 v12, s[24:27], s44 offen nt lds
    s_mov_b32 m0, 41984
    s_add_u32 s44, s40, 37946368
    buffer_load_dwordx4 v13, s[24:27], s44 offen nt lds
    s_mov_b32 m0, 43008
    s_add_u32 s44, s40, 37958656
    buffer_load_dwordx4 v12, s[24:27], s44 offen nt lds
    s_mov_b32 m0, 44032
    s_add_u32 s44, s40, 37958656
    buffer_load_dwordx4 v13, s[24:27], s44 offen nt lds
    s_mov_b32 m0, 8192
    s_add_u32 s44, s40, 197888
    buffer_load_dwordx4 v12, s[24:27], s44 offen nt lds
    s_mov_b32 m0, 9216
    s_add_u32 s44, s40, 197888
    buffer_load_dwordx4 v13, s[24:27], s44 offen nt lds
    s_waitcnt vmcnt(33)
    s_mov_b32 m0, 10240
    s_add_u32 s44, s40, 210176
    buffer_load_dwordx4 v12, s[24:27], s44 offen nt lds
    s_waitcnt vmcnt(33)
    s_mov_b32 m0, 11264
    s_add_u32 s44, s40, 210176
    buffer_load_dwordx4 v13, s[24:27], s44 offen nt lds
    s_waitcnt vmcnt(33)
    s_mov_b32 m0, 20480
    s_add_u32 s44, s40, 12780800
    buffer_load_dwordx4 v12, s[24:27], s44 offen nt lds
    s_waitcnt vmcnt(33)
    s_mov_b32 m0, 21504
    s_add_u32 s44, s40, 12780800
    buffer_load_dwordx4 v13, s[24:27], s44 offen nt lds
    s_waitcnt vmcnt(33)
    s_mov_b32 m0, 22528
    s_add_u32 s44, s40, 12793088
    buffer_load_dwordx4 v12, s[24:27], s44 offen nt lds
    s_waitcnt vmcnt(33)
    s_mov_b32 m0, 23552
    s_add_u32 s44, s40, 12793088
    buffer_load_dwordx4 v13, s[24:27], s44 offen nt lds
    s_waitcnt vmcnt(33)
    s_mov_b32 m0, 32768
    s_add_u32 s44, s40, 25363712
    buffer_load_dwordx4 v12, s[24:27], s44 offen nt lds
    s_waitcnt vmcnt(33)
    s_mov_b32 m0, 33792
    s_add_u32 s44, s40, 25363712
    buffer_load_dwordx4 v13, s[24:27], s44 offen nt lds
    s_waitcnt vmcnt(33)
    s_mov_b32 m0, 34816
    s_add_u32 s44, s40, 25376000
    buffer_load_dwordx4 v12, s[24:27], s44 offen nt lds
    s_waitcnt vmcnt(33)
    s_mov_b32 m0, 35840
    s_add_u32 s44, s40, 25376000
    buffer_load_dwordx4 v13, s[24:27], s44 offen nt lds
    s_waitcnt vmcnt(33)
    s_mov_b32 m0, 45056
    s_add_u32 s44, s40, 37946624
    buffer_load_dwordx4 v12, s[24:27], s44 offen nt lds
    s_waitcnt vmcnt(33)
    s_mov_b32 m0, 46080
    s_add_u32 s44, s40, 37946624
    buffer_load_dwordx4 v13, s[24:27], s44 offen nt lds
    s_waitcnt vmcnt(33)
    s_mov_b32 m0, 47104
    s_add_u32 s44, s40, 37958912
    buffer_load_dwordx4 v12, s[24:27], s44 offen nt lds
    s_waitcnt vmcnt(33)
    s_mov_b32 m0, 48128
    s_add_u32 s44, s40, 37958912
    buffer_load_dwordx4 v13, s[24:27], s44 offen nt lds
    s_waitcnt vmcnt(32)
    v_mov_b32 v6, 10
    ds_write_b32 v15, v6 offset:0
    s_waitcnt vmcnt(16)
    v_mov_b32 v6, 11
    ds_write_b32 v15, v6 offset:0
    s_waitcnt vmcnt(0)
    v_mov_b32 v6, 12
    ds_write_b32 v15, v6 offset:0
    s_branch L_lfin_166
L_shal_165:
    s_mov_b32 m0, 0
    s_add_u32 s44, s40, 197376
    buffer_load_dwordx4 v12, s[24:27], s44 offen nt lds
    s_mov_b32 m0, 1024
    s_add_u32 s44, s40, 197376
    buffer_load_dwordx4 v13, s[24:27], s44 offen nt lds
    s_mov_b32 m0, 2048
    s_add_u32 s44, s40, 209664
    buffer_load_dwordx4 v12, s[24:27], s44 offen nt lds
    s_mov_b32 m0, 3072
    s_add_u32 s44, s40, 209664
    buffer_load_dwordx4 v13, s[24:27], s44 offen nt lds
    s_mov_b32 m0, 12288
    s_add_u32 s44, s40, 12780288
    buffer_load_dwordx4 v12, s[24:27], s44 offen nt lds
    s_mov_b32 m0, 13312
    s_add_u32 s44, s40, 12780288
    buffer_load_dwordx4 v13, s[24:27], s44 offen nt lds
    s_mov_b32 m0, 14336
    s_add_u32 s44, s40, 12792576
    buffer_load_dwordx4 v12, s[24:27], s44 offen nt lds
    s_mov_b32 m0, 15360
    s_add_u32 s44, s40, 12792576
    buffer_load_dwordx4 v13, s[24:27], s44 offen nt lds
    s_mov_b32 m0, 24576
    s_add_u32 s44, s40, 25363200
    buffer_load_dwordx4 v12, s[24:27], s44 offen nt lds
    s_mov_b32 m0, 25600
    s_add_u32 s44, s40, 25363200
    buffer_load_dwordx4 v13, s[24:27], s44 offen nt lds
    s_mov_b32 m0, 26624
    s_add_u32 s44, s40, 25375488
    buffer_load_dwordx4 v12, s[24:27], s44 offen nt lds
    s_mov_b32 m0, 27648
    s_add_u32 s44, s40, 25375488
    buffer_load_dwordx4 v13, s[24:27], s44 offen nt lds
    s_mov_b32 m0, 36864
    s_add_u32 s44, s40, 37946112
    buffer_load_dwordx4 v12, s[24:27], s44 offen nt lds
    s_mov_b32 m0, 37888
    s_add_u32 s44, s40, 37946112
    buffer_load_dwordx4 v13, s[24:27], s44 offen nt lds
    s_mov_b32 m0, 38912
    s_add_u32 s44, s40, 37958400
    buffer_load_dwordx4 v12, s[24:27], s44 offen nt lds
    s_mov_b32 m0, 39936
    s_add_u32 s44, s40, 37958400
    buffer_load_dwordx4 v13, s[24:27], s44 offen nt lds
    s_mov_b32 m0, 4096
    s_add_u32 s44, s40, 197632
    buffer_load_dwordx4 v12, s[24:27], s44 offen nt lds
    s_mov_b32 m0, 5120
    s_add_u32 s44, s40, 197632
    buffer_load_dwordx4 v13, s[24:27], s44 offen nt lds
    s_mov_b32 m0, 6144
    s_add_u32 s44, s40, 209920
    buffer_load_dwordx4 v12, s[24:27], s44 offen nt lds
    s_mov_b32 m0, 7168
    s_add_u32 s44, s40, 209920
    buffer_load_dwordx4 v13, s[24:27], s44 offen nt lds
    s_mov_b32 m0, 16384
    s_add_u32 s44, s40, 12780544
    buffer_load_dwordx4 v12, s[24:27], s44 offen nt lds
    s_mov_b32 m0, 17408
    s_add_u32 s44, s40, 12780544
    buffer_load_dwordx4 v13, s[24:27], s44 offen nt lds
    s_waitcnt vmcnt(21)
    s_mov_b32 m0, 18432
    s_add_u32 s44, s40, 12792832
    buffer_load_dwordx4 v12, s[24:27], s44 offen nt lds
    s_waitcnt vmcnt(21)
    s_mov_b32 m0, 19456
    s_add_u32 s44, s40, 12792832
    buffer_load_dwordx4 v13, s[24:27], s44 offen nt lds
    s_waitcnt vmcnt(21)
    s_mov_b32 m0, 28672
    s_add_u32 s44, s40, 25363456
    buffer_load_dwordx4 v12, s[24:27], s44 offen nt lds
    s_waitcnt vmcnt(21)
    s_mov_b32 m0, 29696
    s_add_u32 s44, s40, 25363456
    buffer_load_dwordx4 v13, s[24:27], s44 offen nt lds
    s_waitcnt vmcnt(21)
    s_mov_b32 m0, 30720
    s_add_u32 s44, s40, 25375744
    buffer_load_dwordx4 v12, s[24:27], s44 offen nt lds
    s_waitcnt vmcnt(21)
    s_mov_b32 m0, 31744
    s_add_u32 s44, s40, 25375744
    buffer_load_dwordx4 v13, s[24:27], s44 offen nt lds
    s_waitcnt vmcnt(21)
    s_mov_b32 m0, 40960
    s_add_u32 s44, s40, 37946368
    buffer_load_dwordx4 v12, s[24:27], s44 offen nt lds
    s_waitcnt vmcnt(21)
    s_mov_b32 m0, 41984
    s_add_u32 s44, s40, 37946368
    buffer_load_dwordx4 v13, s[24:27], s44 offen nt lds
    s_waitcnt vmcnt(21)
    s_mov_b32 m0, 43008
    s_add_u32 s44, s40, 37958656
    buffer_load_dwordx4 v12, s[24:27], s44 offen nt lds
    s_waitcnt vmcnt(21)
    s_mov_b32 m0, 44032
    s_add_u32 s44, s40, 37958656
    buffer_load_dwordx4 v13, s[24:27], s44 offen nt lds
    s_waitcnt vmcnt(21)
    s_mov_b32 m0, 8192
    s_add_u32 s44, s40, 197888
    buffer_load_dwordx4 v12, s[24:27], s44 offen nt lds
    s_waitcnt vmcnt(21)
    s_mov_b32 m0, 9216
    s_add_u32 s44, s40, 197888
    buffer_load_dwordx4 v13, s[24:27], s44 offen nt lds
    s_waitcnt vmcnt(21)
    s_mov_b32 m0, 10240
    s_add_u32 s44, s40, 210176
    buffer_load_dwordx4 v12, s[24:27], s44 offen nt lds
    s_waitcnt vmcnt(21)
    s_mov_b32 m0, 11264
    s_add_u32 s44, s40, 210176
    buffer_load_dwordx4 v13, s[24:27], s44 offen nt lds
    s_waitcnt vmcnt(21)
    s_mov_b32 m0, 20480
    s_add_u32 s44, s40, 12780800
    buffer_load_dwordx4 v12, s[24:27], s44 offen nt lds
    s_waitcnt vmcnt(21)
    v_mov_b32 v6, 10
    ds_write_b32 v15, v6 offset:0
    s_mov_b32 m0, 21504
    s_add_u32 s44, s40, 12780800
    buffer_load_dwordx4 v13, s[24:27], s44 offen nt lds
    s_waitcnt vmcnt(21)
    s_mov_b32 m0, 22528
    s_add_u32 s44, s40, 12793088
    buffer_load_dwordx4 v12, s[24:27], s44 offen nt lds
    s_waitcnt vmcnt(21)
    s_mov_b32 m0, 23552
    s_add_u32 s44, s40, 12793088
    buffer_load_dwordx4 v13, s[24:27], s44 offen nt lds
    s_waitcnt vmcnt(21)
    s_mov_b32 m0, 32768
    s_add_u32 s44, s40, 25363712
    buffer_load_dwordx4 v12, s[24:27], s44 offen nt lds
    s_waitcnt vmcnt(21)
    s_mov_b32 m0, 33792
    s_add_u32 s44, s40, 25363712
    buffer_load_dwordx4 v13, s[24:27], s44 offen nt lds
    s_waitcnt vmcnt(21)
    s_mov_b32 m0, 34816
    s_add_u32 s44, s40, 25376000
    buffer_load_dwordx4 v12, s[24:27], s44 offen nt lds
    s_waitcnt vmcnt(21)
    s_mov_b32 m0, 35840
    s_add_u32 s44, s40, 25376000
    buffer_load_dwordx4 v13, s[24:27], s44 offen nt lds
    s_waitcnt vmcnt(21)
    s_mov_b32 m0, 45056
    s_add_u32 s44, s40, 37946624
    buffer_load_dwordx4 v12, s[24:27], s44 offen nt lds
    s_waitcnt vmcnt(21)
    s_mov_b32 m0, 46080
    s_add_u32 s44, s40, 37946624
    buffer_load_dwordx4 v13, s[24:27], s44 offen nt lds
    s_waitcnt vmcnt(21)
    s_mov_b32 m0, 47104
    s_add_u32 s44, s40, 37958912
    buffer_load_dwordx4 v12, s[24:27], s44 offen nt lds
    s_waitcnt vmcnt(21)
    s_mov_b32 m0, 48128
    s_add_u32 s44, s40, 37958912
    buffer_load_dwordx4 v13, s[24:27], s44 offen nt lds
    s_waitcnt vmcnt(16)
    v_mov_b32 v6, 11
    ds_write_b32 v15, v6 offset:0
    s_waitcnt vmcnt(0)
    v_mov_b32 v6, 12
    ds_write_b32 v15, v6 offset:0
L_lfin_166:
    s_branch L_ldjoin_150
L_ldhold_148:
    s_mov_b32 m0, 6144
    s_add_u32 s44, s41, 6400
    buffer_load_dwordx4 v10, s[28:31], s44 offen nt lds
    s_mov_b32 m0, 7168
    s_add_u32 s44, s41, 6400
    buffer_load_dwordx4 v11, s[28:31], s44 offen nt lds
    s_mov_b32 m0, 16384
    s_add_u32 s44, s41, 3145984
    buffer_load_dwordx4 v10, s[28:31], s44 offen nt lds
    s_mov_b32 m0, 17408
    s_add_u32 s44, s41, 3145984
    buffer_load_dwordx4 v11, s[28:31], s44 offen nt lds
    s_mov_b32 m0, 18432
    s_add_u32 s44, s41, 3152128
    buffer_load_dwordx4 v10, s[28:31], s44 offen nt lds
    s_mov_b32 m0, 19456
    s_add_u32 s44, s41, 3152128
    buffer_load_dwordx4 v11, s[28:31], s44 offen nt lds
    s_mov_b32 m0, 28672
    s_add_u32 s44, s41, 6291712
    buffer_load_dwordx4 v10, s[28:31], s44 offen nt lds
    s_mov_b32 m0, 29696
    s_add_u32 s44, s41, 6291712
    buffer_load_dwordx4 v11, s[28:31], s44 offen nt lds
    s_mov_b32 m0, 30720
    s_add_u32 s44, s41, 6297856
    buffer_load_dwordx4 v10, s[28:31], s44 offen nt lds
    s_mov_b32 m0, 31744
    s_add_u32 s44, s41, 6297856
    buffer_load_dwordx4 v11, s[28:31], s44 offen nt lds
    s_waitcnt vmcnt(27)
    s_mov_b32 m0, 40960
    s_add_u32 s44, s41, 9437440
    buffer_load_dwordx4 v10, s[28:31], s44 offen nt lds
    s_waitcnt vmcnt(27)
    s_mov_b32 m0, 41984
    s_add_u32 s44, s41, 9437440
    buffer_load_dwordx4 v11, s[28:31], s44 offen nt lds
    s_waitcnt vmcnt(27)
    s_mov_b32 m0, 43008
    s_add_u32 s44, s41, 9443584
    buffer_load_dwordx4 v10, s[28:31], s44 offen nt lds
    s_waitcnt vmcnt(27)
    s_mov_b32 m0, 44032
    s_add_u32 s44, s41, 9443584
    buffer_load_dwordx4 v11, s[28:31], s44 offen nt lds
    s_waitcnt vmcnt(27)
    s_mov_b32 m0, 8192
    s_add_u32 s44, s41, 512
    buffer_load_dwordx4 v10, s[28:31], s44 offen nt lds
    s_waitcnt vmcnt(27)
    s_mov_b32 m0, 9216
    s_add_u32 s44, s41, 512
    buffer_load_dwordx4 v11, s[28:31], s44 offen nt lds
    s_waitcnt vmcnt(27)
    s_mov_b32 m0, 10240
    s_add_u32 s44, s41, 6656
    buffer_load_dwordx4 v10, s[28:31], s44 offen nt lds
    s_waitcnt vmcnt(27)
    s_mov_b32 m0, 11264
    s_add_u32 s44, s41, 6656
    buffer_load_dwordx4 v11, s[28:31], s44 offen nt lds
    s_waitcnt vmcnt(27)
    s_mov_b32 m0, 20480
    s_add_u32 s44, s41, 3146240
    buffer_load_dwordx4 v10, s[28:31], s44 offen nt lds
    s_waitcnt vmcnt(27)
    s_mov_b32 m0, 21504
    s_add_u32 s44, s41, 3146240
    buffer_load_dwordx4 v11, s[28:31], s44 offen nt lds
    s_waitcnt vmcnt(27)
    s_mov_b32 m0, 22528
    s_add_u32 s44, s41, 3152384
    buffer_load_dwordx4 v10, s[28:31], s44 offen nt lds
    s_waitcnt vmcnt(27)
    s_mov_b32 m0, 23552
    s_add_u32 s44, s41, 3152384
    buffer_load_dwordx4 v11, s[28:31], s44 offen nt lds
    s_waitcnt vmcnt(27)
    s_mov_b32 m0, 32768
    s_add_u32 s44, s41, 6291968
    buffer_load_dwordx4 v10, s[28:31], s44 offen nt lds
    s_waitcnt vmcnt(27)
    s_mov_b32 m0, 33792
    s_add_u32 s44, s41, 6291968
    buffer_load_dwordx4 v11, s[28:31], s44 offen nt lds
    s_waitcnt vmcnt(27)
    s_mov_b32 m0, 34816
    s_add_u32 s44, s41, 6298112
    buffer_load_dwordx4 v10, s[28:31], s44 offen nt lds
    s_waitcnt vmcnt(27)
    v_mov_b32 v6, 1
    ds_write_b32 v15, v6 offset:0
    s_mov_b32 m0, 35840
    s_add_u32 s44, s41, 6298112
    buffer_load_dwordx4 v11, s[28:31], s44 offen nt lds
    s_waitcnt vmcnt(27)
    s_mov_b32 m0, 45056
    s_add_u32 s44, s41, 9437696
    buffer_load_dwordx4 v10, s[28:31], s44 offen nt lds
    s_waitcnt vmcnt(27)
    s_mov_b32 m0, 46080
    s_add_u32 s44, s41, 9437696
    buffer_load_dwordx4 v11, s[28:31], s44 offen nt lds
    s_waitcnt vmcnt(27)
    s_mov_b32 m0, 47104
    s_add_u32 s44, s41, 9443840
    buffer_load_dwordx4 v10, s[28:31], s44 offen nt lds
    s_waitcnt vmcnt(27)
    s_mov_b32 m0, 48128
    s_add_u32 s44, s41, 9443840
    buffer_load_dwordx4 v11, s[28:31], s44 offen nt lds
    s_waitcnt vmcnt(27)
    s_mov_b32 m0, 49152
    s_add_u32 s44, s40, 0
    buffer_load_dwordx4 v12, s[24:27], s44 offen nt lds
    s_waitcnt vmcnt(27)
    s_mov_b32 m0, 50176
    s_add_u32 s44, s40, 0
    buffer_load_dwordx4 v13, s[24:27], s44 offen nt lds
    s_waitcnt vmcnt(27)
    s_mov_b32 m0, 51200
    s_add_u32 s44, s40, 12288
    buffer_load_dwordx4 v12, s[24:27], s44 offen nt lds
    s_waitcnt vmcnt(27)
    s_mov_b32 m0, 52224
    s_add_u32 s44, s40, 12288
    buffer_load_dwordx4 v13, s[24:27], s44 offen nt lds
    s_waitcnt vmcnt(27)
    s_mov_b32 m0, 61440
    s_add_u32 s44, s40, 12582912
    buffer_load_dwordx4 v12, s[24:27], s44 offen nt lds
    s_waitcnt vmcnt(27)
    s_mov_b32 m0, 62464
    s_add_u32 s44, s40, 12582912
    buffer_load_dwordx4 v13, s[24:27], s44 offen nt lds
    s_waitcnt vmcnt(27)
    s_mov_b32 m0, 63488
    s_add_u32 s44, s40, 12595200
    buffer_load_dwordx4 v12, s[24:27], s44 offen nt lds
    s_waitcnt vmcnt(27)
    s_mov_b32 m0, 64512
    s_add_u32 s44, s40, 12595200
    buffer_load_dwordx4 v13, s[24:27], s44 offen nt lds
    s_waitcnt vmcnt(27)
    s_mov_b32 m0, 73728
    s_add_u32 s44, s40, 25165824
    buffer_load_dwordx4 v12, s[24:27], s44 offen nt lds
    s_waitcnt vmcnt(27)
    s_mov_b32 m0, 74752
    s_add_u32 s44, s40, 25165824
    buffer_load_dwordx4 v13, s[24:27], s44 offen nt lds
    s_waitcnt vmcnt(27)
    s_mov_b32 m0, 75776
    s_add_u32 s44, s40, 25178112
    buffer_load_dwordx4 v12, s[24:27], s44 offen nt lds
    s_waitcnt vmcnt(27)
    v_mov_b32 v6, 2
    ds_write_b32 v15, v6 offset:0
    s_mov_b32 m0, 76800
    s_add_u32 s44, s40, 25178112
    buffer_load_dwordx4 v13, s[24:27], s44 offen nt lds
    s_waitcnt vmcnt(27)
    s_mov_b32 m0, 86016
    s_add_u32 s44, s40, 37748736
    buffer_load_dwordx4 v12, s[24:27], s44 offen nt lds
    s_waitcnt vmcnt(27)
    s_mov_b32 m0, 87040
    s_add_u32 s44, s40, 37748736
    buffer_load_dwordx4 v13, s[24:27], s44 offen nt lds
    s_waitcnt vmcnt(27)
    s_mov_b32 m0, 88064
    s_add_u32 s44, s40, 37761024
    buffer_load_dwordx4 v12, s[24:27], s44 offen nt lds
    s_waitcnt vmcnt(27)
    s_mov_b32 m0, 89088
    s_add_u32 s44, s40, 37761024
    buffer_load_dwordx4 v13, s[24:27], s44 offen nt lds
    s_waitcnt vmcnt(27)
    s_mov_b32 m0, 53248
    s_add_u32 s44, s40, 256
    buffer_load_dwordx4 v12, s[24:27], s44 offen nt lds
    s_waitcnt vmcnt(27)
    s_mov_b32 m0, 54272
    s_add_u32 s44, s40, 256
    buffer_load_dwordx4 v13, s[24:27], s44 offen nt lds
    s_waitcnt vmcnt(27)
    s_mov_b32 m0, 55296
    s_add_u32 s44, s40, 12544
    buffer_load_dwordx4 v12, s[24:27], s44 offen nt lds
    s_waitcnt vmcnt(27)
    s_mov_b32 m0, 56320
    s_add_u32 s44, s40, 12544
    buffer_load_dwordx4 v13, s[24:27], s44 offen nt lds
    s_waitcnt vmcnt(27)
    s_mov_b32 m0, 65536
    s_add_u32 s44, s40, 12583168
    buffer_load_dwordx4 v12, s[24:27], s44 offen nt lds
    s_waitcnt vmcnt(27)
    s_mov_b32 m0, 66560
    s_add_u32 s44, s40, 12583168
    buffer_load_dwordx4 v13, s[24:27], s44 offen nt lds
    s_waitcnt vmcnt(27)
    s_mov_b32 m0, 67584
    s_add_u32 s44, s40, 12595456
    buffer_load_dwordx4 v12, s[24:27], s44 offen nt lds
    s_waitcnt vmcnt(27)
    s_mov_b32 m0, 68608
    s_add_u32 s44, s40, 12595456
    buffer_load_dwordx4 v13, s[24:27], s44 offen nt lds
    s_waitcnt vmcnt(27)
    s_mov_b32 m0, 77824
    s_add_u32 s44, s40, 25166080
    buffer_load_dwordx4 v12, s[24:27], s44 offen nt lds
    s_waitcnt vmcnt(27)
    s_mov_b32 m0, 78848
    s_add_u32 s44, s40, 25166080
    buffer_load_dwordx4 v13, s[24:27], s44 offen nt lds
    s_waitcnt vmcnt(27)
    s_mov_b32 m0, 79872
    s_add_u32 s44, s40, 25178368
    buffer_load_dwordx4 v12, s[24:27], s44 offen nt lds
    s_waitcnt vmcnt(27)
    v_mov_b32 v6, 3
    ds_write_b32 v15, v6 offset:0
    s_mov_b32 m0, 80896
    s_add_u32 s44, s40, 25178368
    buffer_load_dwordx4 v13, s[24:27], s44 offen nt lds
    s_waitcnt vmcnt(27)
    s_mov_b32 m0, 90112
    s_add_u32 s44, s40, 37748992
    buffer_load_dwordx4 v12, s[24:27], s44 offen nt lds
    s_waitcnt vmcnt(27)
    s_mov_b32 m0, 91136
    s_add_u32 s44, s40, 37748992
    buffer_load_dwordx4 v13, s[24:27], s44 offen nt lds
    s_waitcnt vmcnt(27)
    s_mov_b32 m0, 92160
    s_add_u32 s44, s40, 37761280
    buffer_load_dwordx4 v12, s[24:27], s44 offen nt lds
    s_waitcnt vmcnt(27)
    s_mov_b32 m0, 93184
    s_add_u32 s44, s40, 37761280
    buffer_load_dwordx4 v13, s[24:27], s44 offen nt lds
    s_waitcnt vmcnt(27)
    s_mov_b32 m0, 57344
    s_add_u32 s44, s40, 512
    buffer_load_dwordx4 v12, s[24:27], s44 offen nt lds
    s_waitcnt vmcnt(27)
    s_mov_b32 m0, 58368
    s_add_u32 s44, s40, 512
    buffer_load_dwordx4 v13, s[24:27], s44 offen nt lds
    s_waitcnt vmcnt(27)
    s_mov_b32 m0, 59392
    s_add_u32 s44, s40, 12800
    buffer_load_dwordx4 v12, s[24:27], s44 offen nt lds
    s_waitcnt vmcnt(27)
    s_mov_b32 m0, 60416
    s_add_u32 s44, s40, 12800
    buffer_load_dwordx4 v13, s[24:27], s44 offen nt lds
    s_waitcnt vmcnt(27)
    s_mov_b32 m0, 69632
    s_add_u32 s44, s40, 12583424
    buffer_load_dwordx4 v12, s[24:27], s44 offen nt lds
    s_waitcnt vmcnt(27)
    s_mov_b32 m0, 70656
    s_add_u32 s44, s40, 12583424
    buffer_load_dwordx4 v13, s[24:27], s44 offen nt lds
    s_waitcnt vmcnt(27)
    s_mov_b32 m0, 71680
    s_add_u32 s44, s40, 12595712
    buffer_load_dwordx4 v12, s[24:27], s44 offen nt lds
    s_waitcnt vmcnt(27)
    s_mov_b32 m0, 72704
    s_add_u32 s44, s40, 12595712
    buffer_load_dwordx4 v13, s[24:27], s44 offen nt lds
    s_waitcnt vmcnt(27)
    s_mov_b32 m0, 81920
    s_add_u32 s44, s40, 25166336
    buffer_load_dwordx4 v12, s[24:27], s44 offen nt lds
    s_waitcnt vmcnt(27)
    s_mov_b32 m0, 82944
    s_add_u32 s44, s40, 25166336
    buffer_load_dwordx4 v13, s[24:27], s44 offen nt lds
    s_waitcnt vmcnt(27)
    s_mov_b32 m0, 83968
    s_add_u32 s44, s40, 25178624
    buffer_load_dwordx4 v12, s[24:27], s44 offen nt lds
    s_waitcnt vmcnt(27)
    v_mov_b32 v6, 4
    ds_write_b32 v15, v6 offset:0
    s_mov_b32 m0, 84992
    s_add_u32 s44, s40, 25178624
    buffer_load_dwordx4 v13, s[24:27], s44 offen nt lds
    s_waitcnt vmcnt(27)
    s_mov_b32 m0, 94208
    s_add_u32 s44, s40, 37749248
    buffer_load_dwordx4 v12, s[24:27], s44 offen nt lds
    s_waitcnt vmcnt(27)
    s_mov_b32 m0, 95232
    s_add_u32 s44, s40, 37749248
    buffer_load_dwordx4 v13, s[24:27], s44 offen nt lds
    s_waitcnt vmcnt(27)
    s_mov_b32 m0, 96256
    s_add_u32 s44, s40, 37761536
    buffer_load_dwordx4 v12, s[24:27], s44 offen nt lds
    s_waitcnt vmcnt(27)
    s_mov_b32 m0, 97280
    s_add_u32 s44, s40, 37761536
    buffer_load_dwordx4 v13, s[24:27], s44 offen nt lds
L_spin_167:
    ds_read_b128 v[16:19], v15 offset:64
    s_waitcnt lgkmcnt(0)
    v_min3_u32 v16, v16, v17, v18
    v_min_u32 v16, v16, v19
    s_nop 0
    v_readfirstlane_b32 s61, v16
    s_nop 0
    s_cmp_ge_u32 s61, 1
    s_cbranch_scc0 L_retry_169
L_done_168:
    s_waitcnt vmcnt(27)
    s_mov_b32 m0, 98304
    s_add_u32 s44, s40, 768
    buffer_load_dwordx4 v12, s[24:27], s44 offen nt lds
    s_waitcnt vmcnt(27)
    s_mov_b32 m0, 99328
    s_add_u32 s44, s40, 768
    buffer_load_dwordx4 v13, s[24:27], s44 offen nt lds
    s_waitcnt vmcnt(27)
    s_mov_b32 m0, 100352
    s_add_u32 s44, s40, 13056
    buffer_load_dwordx4 v12, s[24:27], s44 offen nt lds
    s_waitcnt vmcnt(27)
    s_mov_b32 m0, 101376
    s_add_u32 s44, s40, 13056
    buffer_load_dwordx4 v13, s[24:27], s44 offen nt lds
    s_waitcnt vmcnt(27)
    s_mov_b32 m0, 110592
    s_add_u32 s44, s40, 12583680
    buffer_load_dwordx4 v12, s[24:27], s44 offen nt lds
    s_waitcnt vmcnt(27)
    s_mov_b32 m0, 111616
    s_add_u32 s44, s40, 12583680
    buffer_load_dwordx4 v13, s[24:27], s44 offen nt lds
    s_waitcnt vmcnt(27)
    s_mov_b32 m0, 112640
    s_add_u32 s44, s40, 12595968
    buffer_load_dwordx4 v12, s[24:27], s44 offen nt lds
    s_waitcnt vmcnt(27)
    s_mov_b32 m0, 113664
    s_add_u32 s44, s40, 12595968
    buffer_load_dwordx4 v13, s[24:27], s44 offen nt lds
    s_waitcnt vmcnt(27)
    s_mov_b32 m0, 122880
    s_add_u32 s44, s40, 25166592
    buffer_load_dwordx4 v12, s[24:27], s44 offen nt lds
    s_waitcnt vmcnt(27)
    s_mov_b32 m0, 123904
    s_add_u32 s44, s40, 25166592
    buffer_load_dwordx4 v13, s[24:27], s44 offen nt lds
    s_waitcnt vmcnt(27)
    s_mov_b32 m0, 124928
    s_add_u32 s44, s40, 25178880
    buffer_load_dwordx4 v12, s[24:27], s44 offen nt lds
    s_waitcnt vmcnt(27)
    v_mov_b32 v6, 5
    ds_write_b32 v15, v6 offset:0
    s_mov_b32 m0, 125952
    s_add_u32 s44, s40, 25178880
    buffer_load_dwordx4 v13, s[24:27], s44 offen nt lds
    s_waitcnt vmcnt(27)
    s_mov_b32 m0, 135168
    s_add_u32 s44, s40, 37749504
    buffer_load_dwordx4 v12, s[24:27], s44 offen nt lds
    s_waitcnt vmcnt(27)
    s_mov_b32 m0, 136192
    s_add_u32 s44, s40, 37749504
    buffer_load_dwordx4 v13, s[24:27], s44 offen nt lds
    s_waitcnt vmcnt(27)
    s_mov_b32 m0, 137216
    s_add_u32 s44, s40, 37761792
    buffer_load_dwordx4 v12, s[24:27], s44 offen nt lds
    s_waitcnt vmcnt(27)
    s_mov_b32 m0, 138240
    s_add_u32 s44, s40, 37761792
    buffer_load_dwordx4 v13, s[24:27], s44 offen nt lds
    s_waitcnt vmcnt(27)
    s_mov_b32 m0, 102400
    s_add_u32 s44, s40, 1024
    buffer_load_dwordx4 v12, s[24:27], s44 offen nt lds
    s_waitcnt vmcnt(27)
    s_mov_b32 m0, 103424
    s_add_u32 s44, s40, 1024
    buffer_load_dwordx4 v13, s[24:27], s44 offen nt lds
    s_waitcnt vmcnt(27)
    s_mov_b32 m0, 104448
    s_add_u32 s44, s40, 13312
    buffer_load_dwordx4 v12, s[24:27], s44 offen nt lds
    s_waitcnt vmcnt(27)
    s_mov_b32 m0, 105472
    s_add_u32 s44, s40, 13312
    buffer_load_dwordx4 v13, s[24:27], s44 offen nt lds
    s_waitcnt vmcnt(27)
    s_mov_b32 m0, 114688
    s_add_u32 s44, s40, 12583936
    buffer_load_dwordx4 v12, s[24:27], s44 offen nt lds
    s_waitcnt vmcnt(27)
    s_mov_b32 m0, 115712
    s_add_u32 s44, s40, 12583936
    buffer_load_dwordx4 v13, s[24:27], s44 offen nt lds
    s_waitcnt vmcnt(27)
    s_mov_b32 m0, 116736
    s_add_u32 s44, s40, 12596224
    buffer_load_dwordx4 v12, s[24:27], s44 offen nt lds
    s_waitcnt vmcnt(27)
    s_mov_b32 m0, 117760
    s_add_u32 s44, s40, 12596224
    buffer_load_dwordx4 v13, s[24:27], s44 offen nt lds
    s_waitcnt vmcnt(27)
    s_mov_b32 m0, 126976
    s_add_u32 s44, s40, 25166848
    buffer_load_dwordx4 v12, s[24:27], s44 offen nt lds
    s_waitcnt vmcnt(27)
    s_mov_b32 m0, 128000
    s_add_u32 s44, s40, 25166848
    buffer_load_dwordx4 v13, s[24:27], s44 offen nt lds
    s_waitcnt vmcnt(27)
    s_mov_b32 m0, 129024
    s_add_u32 s44, s40, 25179136
    buffer_load_dwordx4 v12, s[24:27], s44 offen nt lds
    s_waitcnt vmcnt(27)
    v_mov_b32 v6, 6
    ds_write_b32 v15, v6 offset:0
    s_mov_b32 m0, 130048
    s_add_u32 s44, s40, 25179136
    buffer_load_dwordx4 v13, s[24:27], s44 offen nt lds
    s_waitcnt vmcnt(27)
    s_mov_b32 m0, 139264
    s_add_u32 s44, s40, 37749760
    buffer_load_dwordx4 v12, s[24:27], s44 offen nt lds
    s_waitcnt vmcnt(27)
    s_mov_b32 m0, 140288
    s_add_u32 s44, s40, 37749760
    buffer_load_dwordx4 v13, s[24:27], s44 offen nt lds
    s_waitcnt vmcnt(27)
    s_mov_b32 m0, 141312
    s_add_u32 s44, s40, 37762048
    buffer_load_dwordx4 v12, s[24:27], s44 offen nt lds
    s_waitcnt vmcnt(27)
    s_mov_b32 m0, 142336
    s_add_u32 s44, s40, 37762048
    buffer_load_dwordx4 v13, s[24:27], s44 offen nt lds
    s_waitcnt vmcnt(27)
    s_mov_b32 m0, 106496
    s_add_u32 s44, s40, 1280
    buffer_load_dwordx4 v12, s[24:27], s44 offen nt lds
    s_waitcnt vmcnt(27)
    s_mov_b32 m0, 107520
    s_add_u32 s44, s40, 1280
    buffer_load_dwordx4 v13, s[24:27], s44 offen nt lds
    s_waitcnt vmcnt(27)
    s_mov_b32 m0, 108544
    s_add_u32 s44, s40, 13568
    buffer_load_dwordx4 v12, s[24:27], s44 offen nt lds
    s_waitcnt vmcnt(27)
    s_mov_b32 m0, 109568
    s_add_u32 s44, s40, 13568
    buffer_load_dwordx4 v13, s[24:27], s44 offen nt lds
    s_waitcnt vmcnt(27)
    s_mov_b32 m0, 118784
    s_add_u32 s44, s40, 12584192
    buffer_load_dwordx4 v12, s[24:27], s44 offen nt lds
    s_waitcnt vmcnt(27)
    s_mov_b32 m0, 119808
    s_add_u32 s44, s40, 12584192
    buffer_load_dwordx4 v13, s[24:27], s44 offen nt lds
    s_waitcnt vmcnt(27)
    s_mov_b32 m0, 120832
    s_add_u32 s44, s40, 12596480
    buffer_load_dwordx4 v12, s[24:27], s44 offen nt lds
    s_waitcnt vmcnt(27)
    s_mov_b32 m0, 121856
    s_add_u32 s44, s40, 12596480
    buffer_load_dwordx4 v13, s[24:27], s44 offen nt lds
    s_waitcnt vmcnt(27)
    s_mov_b32 m0, 131072
    s_add_u32 s44, s40, 25167104
    buffer_load_dwordx4 v12, s[24:27], s44 offen nt lds
    s_waitcnt vmcnt(27)
    s_mov_b32 m0, 132096
    s_add_u32 s44, s40, 25167104
    buffer_load_dwordx4 v13, s[24:27], s44 offen nt lds
    s_waitcnt vmcnt(27)
    s_mov_b32 m0, 133120
    s_add_u32 s44, s40, 25179392
    buffer_load_dwordx4 v12, s[24:27], s44 offen nt lds
    s_waitcnt vmcnt(27)
    v_mov_b32 v6, 7
    ds_write_b32 v15, v6 offset:0
    s_mov_b32 m0, 134144
    s_add_u32 s44, s40, 25179392
    buffer_load_dwordx4 v13, s[24:27], s44 offen nt lds
    s_waitcnt vmcnt(27)
    s_mov_b32 m0, 143360
    s_add_u32 s44, s40, 37750016
    buffer_load_dwordx4 v12, s[24:27], s44 offen nt lds
    s_waitcnt vmcnt(27)
    s_mov_b32 m0, 144384
    s_add_u32 s44, s40, 37750016
    buffer_load_dwordx4 v13, s[24:27], s44 offen nt lds
    s_waitcnt vmcnt(27)
    s_mov_b32 m0, 145408
    s_add_u32 s44, s40, 37762304
    buffer_load_dwordx4 v12, s[24:27], s44 offen nt lds
    s_waitcnt vmcnt(27)
    s_mov_b32 m0, 146432
    s_add_u32 s44, s40, 37762304
    buffer_load_dwordx4 v13, s[24:27], s44 offen nt lds
    v_mov_b32 v6, 1
    ds_write_b32 v15, v6 offset:12
    s_waitcnt vmcnt(16)
    v_mov_b32 v6, 8
    ds_write_b32 v15, v6 offset:0
    s_waitcnt vmcnt(0)
    v_mov_b32 v6, 9
    ds_write_b32 v15, v6 offset:0
L_spin_170:
    ds_read_b64 v[16:17], v15 offset:248
    s_waitcnt lgkmcnt(0)
    v_min_u32 v16, v16, v17
    s_nop 0
    v_readfirstlane_b32 s61, v16
    s_nop 0
    s_cmp_ge_u32 s61, 1
    s_cbranch_scc0 L_retry_172
L_done_171:
L_spin_173:
    ds_read_b128 v[16:19], v15 offset:16
    s_waitcnt lgkmcnt(0)
    v_min3_u32 v16, v16, v17, v18
    v_min_u32 v16, v16, v19
    s_nop 0
    v_readfirstlane_b32 s61, v16
    s_nop 0
    s_cmp_ge_u32 s61, 1
    s_cbranch_scc0 L_retry_175
L_done_174:
L_spin_176:
    ds_read_b64 v[16:17], v15 offset:272
    s_waitcnt lgkmcnt(0)
    v_min_u32 v16, v16, v17
    s_nop 0
    v_readfirstlane_b32 s61, v16
    s_nop 0
    s_cmp_ge_u32 s61, 1
    s_cbranch_scc0 L_retry_178
L_done_177:
    ds_read_b32 v16, v15 offset:4
    s_waitcnt lgkmcnt(0)
    v_readfirstlane_b32 s61, v16
    s_nop 0
    s_cmp_eq_u32 s61, 0
    s_cbranch_scc1 L_shal_179
    s_mov_b32 m0, 0
    s_add_u32 s44, s40, 197376
    buffer_load_dwordx4 v12, s[24:27], s44 offen nt lds
    s_mov_b32 m0, 1024
    s_add_u32 s44, s40, 197376
    buffer_load_dwordx4 v13, s[24:27], s44 offen nt lds
    s_mov_b32 m0, 2048
    s_add_u32 s44, s40, 209664
    buffer_load_dwordx4 v12, s[24:27], s44 offen nt lds
    s_mov_b32 m0, 3072
    s_add_u32 s44, s40, 209664
    buffer_load_dwordx4 v13, s[24:27], s44 offen nt lds
    s_mov_b32 m0, 12288
    s_add_u32 s44, s40, 12780288
    buffer_load_dwordx4 v12, s[24:27], s44 offen nt lds
    s_mov_b32 m0, 13312
    s_add_u32 s44, s40, 12780288
    buffer_load_dwordx4 v13, s[24:27], s44 offen nt lds
    s_mov_b32 m0, 14336
    s_add_u32 s44, s40, 12792576
    buffer_load_dwordx4 v12, s[24:27], s44 offen nt lds
    s_mov_b32 m0, 15360
    s_add_u32 s44, s40, 12792576
    buffer_load_dwordx4 v13, s[24:27], s44 offen nt lds
    s_mov_b32 m0, 24576
    s_add_u32 s44, s40, 25363200
    buffer_load_dwordx4 v12, s[24:27], s44 offen nt lds
    s_mov_b32 m0, 25600
    s_add_u32 s44, s40, 25363200
    buffer_load_dwordx4 v13, s[24:27], s44 offen nt lds
    s_mov_b32 m0, 26624
    s_add_u32 s44, s40, 25375488
    buffer_load_dwordx4 v12, s[24:27], s44 offen nt lds
    s_mov_b32 m0, 27648
    s_add_u32 s44, s40, 25375488
    buffer_load_dwordx4 v13, s[24:27], s44 offen nt lds
    s_mov_b32 m0, 36864
    s_add_u32 s44, s40, 37946112
    buffer_load_dwordx4 v12, s[24:27], s44 offen nt lds
    s_mov_b32 m0, 37888
    s_add_u32 s44, s40, 37946112
    buffer_load_dwordx4 v13, s[24:27], s44 offen nt lds
    s_mov_b32 m0, 38912
    s_add_u32 s44, s40, 37958400
    buffer_load_dwordx4 v12, s[24:27], s44 offen nt lds
    s_mov_b32 m0, 39936
    s_add_u32 s44, s40, 37958400
    buffer_load_dwordx4 v13, s[24:27], s44 offen nt lds
    s_mov_b32 m0, 4096
    s_add_u32 s44, s40, 197632
    buffer_load_dwordx4 v12, s[24:27], s44 offen nt lds
    s_mov_b32 m0, 5120
    s_add_u32 s44, s40, 197632
    buffer_load_dwordx4 v13, s[24:27], s44 offen nt lds
    s_mov_b32 m0, 6144
    s_add_u32 s44, s40, 209920
    buffer_load_dwordx4 v12, s[24:27], s44 offen nt lds
    s_mov_b32 m0, 7168
    s_add_u32 s44, s40, 209920
    buffer_load_dwordx4 v13, s[24:27], s44 offen nt lds
    s_mov_b32 m0, 16384
    s_add_u32 s44, s40, 12780544
    buffer_load_dwordx4 v12, s[24:27], s44 offen nt lds
    s_mov_b32 m0, 17408
    s_add_u32 s44, s40, 12780544
    buffer_load_dwordx4 v13, s[24:27], s44 offen nt lds
    s_mov_b32 m0, 18432
    s_add_u32 s44, s40, 12792832
    buffer_load_dwordx4 v12, s[24:27], s44 offen nt lds
    s_mov_b32 m0, 19456
    s_add_u32 s44, s40, 12792832
    buffer_load_dwordx4 v13, s[24:27], s44 offen nt lds
    s_mov_b32 m0, 28672
    s_add_u32 s44, s40, 25363456
    buffer_load_dwordx4 v12, s[24:27], s44 offen nt lds
    s_mov_b32 m0, 29696
    s_add_u32 s44, s40, 25363456
    buffer_load_dwordx4 v13, s[24:27], s44 offen nt lds
    s_mov_b32 m0, 30720
    s_add_u32 s44, s40, 25375744
    buffer_load_dwordx4 v12, s[24:27], s44 offen nt lds
    s_mov_b32 m0, 31744
    s_add_u32 s44, s40, 25375744
    buffer_load_dwordx4 v13, s[24:27], s44 offen nt lds
    s_mov_b32 m0, 40960
    s_add_u32 s44, s40, 37946368
    buffer_load_dwordx4 v12, s[24:27], s44 offen nt lds
    s_mov_b32 m0, 41984
    s_add_u32 s44, s40, 37946368
    buffer_load_dwordx4 v13, s[24:27], s44 offen nt lds
    s_mov_b32 m0, 43008
    s_add_u32 s44, s40, 37958656
    buffer_load_dwordx4 v12, s[24:27], s44 offen nt lds
    s_mov_b32 m0, 44032
    s_add_u32 s44, s40, 37958656
    buffer_load_dwordx4 v13, s[24:27], s44 offen nt lds
    s_mov_b32 m0, 8192
    s_add_u32 s44, s40, 197888
    buffer_load_dwordx4 v12, s[24:27], s44 offen nt lds
    s_mov_b32 m0, 9216
    s_add_u32 s44, s40, 197888
    buffer_load_dwordx4 v13, s[24:27], s44 offen nt lds
    s_waitcnt vmcnt(33)
    s_mov_b32 m0, 10240
    s_add_u32 s44, s40, 210176
    buffer_load_dwordx4 v12, s[24:27], s44 offen nt lds
    s_waitcnt vmcnt(33)
    s_mov_b32 m0, 11264
    s_add_u32 s44, s40, 210176
    buffer_load_dwordx4 v13, s[24:27], s44 offen nt lds
    s_waitcnt vmcnt(33)
    s_mov_b32 m0, 20480
    s_add_u32 s44, s40, 12780800
    buffer_load_dwordx4 v12, s[24:27], s44 offen nt lds
    s_waitcnt vmcnt(33)
    s_mov_b32 m0, 21504
    s_add_u32 s44, s40, 12780800
    buffer_load_dwordx4 v13, s[24:27], s44 offen nt lds
    s_waitcnt vmcnt(33)
    s_mov_b32 m0, 22528
    s_add_u32 s44, s40, 12793088
    buffer_load_dwordx4 v12, s[24:27], s44 offen nt lds
    s_waitcnt vmcnt(33)
    s_mov_b32 m0, 23552
    s_add_u32 s44, s40, 12793088
    buffer_load_dwordx4 v13, s[24:27], s44 offen nt lds
    s_waitcnt vmcnt(33)
    s_mov_b32 m0, 32768
    s_add_u32 s44, s40, 25363712
    buffer_load_dwordx4 v12, s[24:27], s44 offen nt lds
    s_waitcnt vmcnt(33)
    s_mov_b32 m0, 33792
    s_add_u32 s44, s40, 25363712
    buffer_load_dwordx4 v13, s[24:27], s44 offen nt lds
    s_waitcnt vmcnt(33)
    s_mov_b32 m0, 34816
    s_add_u32 s44, s40, 25376000
    buffer_load_dwordx4 v12, s[24:27], s44 offen nt lds
    s_waitcnt vmcnt(33)
    s_mov_b32 m0, 35840
    s_add_u32 s44, s40, 25376000
    buffer_load_dwordx4 v13, s[24:27], s44 offen nt lds
    s_waitcnt vmcnt(33)
    s_mov_b32 m0, 45056
    s_add_u32 s44, s40, 37946624
    buffer_load_dwordx4 v12, s[24:27], s44 offen nt lds
    s_waitcnt vmcnt(33)
    s_mov_b32 m0, 46080
    s_add_u32 s44, s40, 37946624
    buffer_load_dwordx4 v13, s[24:27], s44 offen nt lds
    s_waitcnt vmcnt(33)
    s_mov_b32 m0, 47104
    s_add_u32 s44, s40, 37958912
    buffer_load_dwordx4 v12, s[24:27], s44 offen nt lds
    s_waitcnt vmcnt(33)
    s_mov_b32 m0, 48128
    s_add_u32 s44, s40, 37958912
    buffer_load_dwordx4 v13, s[24:27], s44 offen nt lds
    s_waitcnt vmcnt(32)
    v_mov_b32 v6, 10
    ds_write_b32 v15, v6 offset:0
    s_waitcnt vmcnt(16)
    v_mov_b32 v6, 11
    ds_write_b32 v15, v6 offset:0
    s_waitcnt vmcnt(0)
    v_mov_b32 v6, 12
    ds_write_b32 v15, v6 offset:0
    s_branch L_lfin_180
L_shal_179:
    s_mov_b32 m0, 0
    s_add_u32 s44, s40, 197376
    buffer_load_dwordx4 v12, s[24:27], s44 offen nt lds
    s_mov_b32 m0, 1024
    s_add_u32 s44, s40, 197376
    buffer_load_dwordx4 v13, s[24:27], s44 offen nt lds
    s_mov_b32 m0, 2048
    s_add_u32 s44, s40, 209664
    buffer_load_dwordx4 v12, s[24:27], s44 offen nt lds
    s_mov_b32 m0, 3072
    s_add_u32 s44, s40, 209664
    buffer_load_dwordx4 v13, s[24:27], s44 offen nt lds
    s_mov_b32 m0, 12288
    s_add_u32 s44, s40, 12780288
    buffer_load_dwordx4 v12, s[24:27], s44 offen nt lds
    s_mov_b32 m0, 13312
    s_add_u32 s44, s40, 12780288
    buffer_load_dwordx4 v13, s[24:27], s44 offen nt lds
    s_mov_b32 m0, 14336
    s_add_u32 s44, s40, 12792576
    buffer_load_dwordx4 v12, s[24:27], s44 offen nt lds
    s_mov_b32 m0, 15360
    s_add_u32 s44, s40, 12792576
    buffer_load_dwordx4 v13, s[24:27], s44 offen nt lds
    s_mov_b32 m0, 24576
    s_add_u32 s44, s40, 25363200
    buffer_load_dwordx4 v12, s[24:27], s44 offen nt lds
    s_mov_b32 m0, 25600
    s_add_u32 s44, s40, 25363200
    buffer_load_dwordx4 v13, s[24:27], s44 offen nt lds
    s_mov_b32 m0, 26624
    s_add_u32 s44, s40, 25375488
    buffer_load_dwordx4 v12, s[24:27], s44 offen nt lds
    s_mov_b32 m0, 27648
    s_add_u32 s44, s40, 25375488
    buffer_load_dwordx4 v13, s[24:27], s44 offen nt lds
    s_mov_b32 m0, 36864
    s_add_u32 s44, s40, 37946112
    buffer_load_dwordx4 v12, s[24:27], s44 offen nt lds
    s_mov_b32 m0, 37888
    s_add_u32 s44, s40, 37946112
    buffer_load_dwordx4 v13, s[24:27], s44 offen nt lds
    s_mov_b32 m0, 38912
    s_add_u32 s44, s40, 37958400
    buffer_load_dwordx4 v12, s[24:27], s44 offen nt lds
    s_mov_b32 m0, 39936
    s_add_u32 s44, s40, 37958400
    buffer_load_dwordx4 v13, s[24:27], s44 offen nt lds
    s_mov_b32 m0, 4096
    s_add_u32 s44, s40, 197632
    buffer_load_dwordx4 v12, s[24:27], s44 offen nt lds
    s_mov_b32 m0, 5120
    s_add_u32 s44, s40, 197632
    buffer_load_dwordx4 v13, s[24:27], s44 offen nt lds
    s_mov_b32 m0, 6144
    s_add_u32 s44, s40, 209920
    buffer_load_dwordx4 v12, s[24:27], s44 offen nt lds
    s_mov_b32 m0, 7168
    s_add_u32 s44, s40, 209920
    buffer_load_dwordx4 v13, s[24:27], s44 offen nt lds
    s_mov_b32 m0, 16384
    s_add_u32 s44, s40, 12780544
    buffer_load_dwordx4 v12, s[24:27], s44 offen nt lds
    s_mov_b32 m0, 17408
    s_add_u32 s44, s40, 12780544
    buffer_load_dwordx4 v13, s[24:27], s44 offen nt lds
    s_mov_b32 m0, 18432
    s_add_u32 s44, s40, 12792832
    buffer_load_dwordx4 v12, s[24:27], s44 offen nt lds
    s_mov_b32 m0, 19456
    s_add_u32 s44, s40, 12792832
    buffer_load_dwordx4 v13, s[24:27], s44 offen nt lds
    s_mov_b32 m0, 28672
    s_add_u32 s44, s40, 25363456
    buffer_load_dwordx4 v12, s[24:27], s44 offen nt lds
    s_mov_b32 m0, 29696
    s_add_u32 s44, s40, 25363456
    buffer_load_dwordx4 v13, s[24:27], s44 offen nt lds
    s_mov_b32 m0, 30720
    s_add_u32 s44, s40, 25375744
    buffer_load_dwordx4 v12, s[24:27], s44 offen nt lds
    s_mov_b32 m0, 31744
    s_add_u32 s44, s40, 25375744
    buffer_load_dwordx4 v13, s[24:27], s44 offen nt lds
    s_mov_b32 m0, 40960
    s_add_u32 s44, s40, 37946368
    buffer_load_dwordx4 v12, s[24:27], s44 offen nt lds
    s_mov_b32 m0, 41984
    s_add_u32 s44, s40, 37946368
    buffer_load_dwordx4 v13, s[24:27], s44 offen nt lds
    s_mov_b32 m0, 43008
    s_add_u32 s44, s40, 37958656
    buffer_load_dwordx4 v12, s[24:27], s44 offen nt lds
    s_mov_b32 m0, 44032
    s_add_u32 s44, s40, 37958656
    buffer_load_dwordx4 v13, s[24:27], s44 offen nt lds
    s_waitcnt vmcnt(31)
    s_mov_b32 m0, 8192
    s_add_u32 s44, s40, 197888
    buffer_load_dwordx4 v12, s[24:27], s44 offen nt lds
    s_waitcnt vmcnt(31)
    s_mov_b32 m0, 9216
    s_add_u32 s44, s40, 197888
    buffer_load_dwordx4 v13, s[24:27], s44 offen nt lds
    s_waitcnt vmcnt(31)
    s_mov_b32 m0, 10240
    s_add_u32 s44, s40, 210176
    buffer_load_dwordx4 v12, s[24:27], s44 offen nt lds
    s_waitcnt vmcnt(31)
    s_mov_b32 m0, 11264
    s_add_u32 s44, s40, 210176
    buffer_load_dwordx4 v13, s[24:27], s44 offen nt lds
    s_waitcnt vmcnt(31)
    s_mov_b32 m0, 20480
    s_add_u32 s44, s40, 12780800
    buffer_load_dwordx4 v12, s[24:27], s44 offen nt lds
    s_waitcnt vmcnt(31)
    s_mov_b32 m0, 21504
    s_add_u32 s44, s40, 12780800
    buffer_load_dwordx4 v13, s[24:27], s44 offen nt lds
    s_waitcnt vmcnt(31)
    s_mov_b32 m0, 22528
    s_add_u32 s44, s40, 12793088
    buffer_load_dwordx4 v12, s[24:27], s44 offen nt lds
    s_waitcnt vmcnt(31)
    s_mov_b32 m0, 23552
    s_add_u32 s44, s40, 12793088
    buffer_load_dwordx4 v13, s[24:27], s44 offen nt lds
    s_waitcnt vmcnt(31)
    s_mov_b32 m0, 32768
    s_add_u32 s44, s40, 25363712
    buffer_load_dwordx4 v12, s[24:27], s44 offen nt lds
    s_waitcnt vmcnt(31)
    s_mov_b32 m0, 33792
    s_add_u32 s44, s40, 25363712
    buffer_load_dwordx4 v13, s[24:27], s44 offen nt lds
    s_waitcnt vmcnt(31)
    s_mov_b32 m0, 34816
    s_add_u32 s44, s40, 25376000
    buffer_load_dwordx4 v12, s[24:27], s44 offen nt lds
    s_waitcnt vmcnt(31)
    s_mov_b32 m0, 35840
    s_add_u32 s44, s40, 25376000
    buffer_load_dwordx4 v13, s[24:27], s44 offen nt lds
    s_waitcnt vmcnt(31)
    s_mov_b32 m0, 45056
    s_add_u32 s44, s40, 37946624
    buffer_load_dwordx4 v12, s[24:27], s44 offen nt lds
    s_waitcnt vmcnt(31)
    s_mov_b32 m0, 46080
    s_add_u32 s44, s40, 37946624
    buffer_load_dwordx4 v13, s[24:27], s44 offen nt lds
    s_waitcnt vmcnt(31)
    s_mov_b32 m0, 47104
    s_add_u32 s44, s40, 37958912
    buffer_load_dwordx4 v12, s[24:27], s44 offen nt lds
    s_waitcnt vmcnt(31)
    v_mov_b32 v6, 10
    ds_write_b32 v15, v6 offset:0
    s_mov_b32 m0, 48128
    s_add_u32 s44, s40, 37958912
    buffer_load_dwordx4 v13, s[24:27], s44 offen nt lds
    s_waitcnt vmcnt(16)
    v_mov_b32 v6, 11
    ds_write_b32 v15, v6 offset:0
    s_waitcnt vmcnt(0)
    v_mov_b32 v6, 12
    ds_write_b32 v15, v6 offset:0
L_lfin_180:
    s_branch L_ldjoin_150
L_ldrole_149:
    s_mov_b32 m0, 6144
    s_add_u32 s44, s41, 6400
    buffer_load_dwordx4 v10, s[28:31], s44 offen nt lds
    s_mov_b32 m0, 7168
    s_add_u32 s44, s41, 6400
    buffer_load_dwordx4 v11, s[28:31], s44 offen nt lds
    s_mov_b32 m0, 16384
    s_add_u32 s44, s41, 3145984
    buffer_load_dwordx4 v10, s[28:31], s44 offen nt lds
    s_mov_b32 m0, 17408
    s_add_u32 s44, s41, 3145984
    buffer_load_dwordx4 v11, s[28:31], s44 offen nt lds
    s_mov_b32 m0, 18432
    s_add_u32 s44, s41, 3152128
    buffer_load_dwordx4 v10, s[28:31], s44 offen nt lds
    s_mov_b32 m0, 19456
    s_add_u32 s44, s41, 3152128
    buffer_load_dwordx4 v11, s[28:31], s44 offen nt lds
    s_mov_b32 m0, 28672
    s_add_u32 s44, s41, 6291712
    buffer_load_dwordx4 v10, s[28:31], s44 offen nt lds
    s_mov_b32 m0, 29696
    s_add_u32 s44, s41, 6291712
    buffer_load_dwordx4 v11, s[28:31], s44 offen nt lds
    s_waitcnt vmcnt(25)
    s_mov_b32 m0, 30720
    s_add_u32 s44, s41, 6297856
    buffer_load_dwordx4 v10, s[28:31], s44 offen nt lds
    s_waitcnt vmcnt(25)
    s_mov_b32 m0, 31744
    s_add_u32 s44, s41, 6297856
    buffer_load_dwordx4 v11, s[28:31], s44 offen nt lds
    s_waitcnt vmcnt(25)
    s_mov_b32 m0, 40960
    s_add_u32 s44, s41, 9437440
    buffer_load_dwordx4 v10, s[28:31], s44 offen nt lds
    s_waitcnt vmcnt(25)
    s_mov_b32 m0, 41984
    s_add_u32 s44, s41, 9437440
    buffer_load_dwordx4 v11, s[28:31], s44 offen nt lds
    s_waitcnt vmcnt(25)
    s_mov_b32 m0, 43008
    s_add_u32 s44, s41, 9443584
    buffer_load_dwordx4 v10, s[28:31], s44 offen nt lds
    s_waitcnt vmcnt(25)
    s_mov_b32 m0, 44032
    s_add_u32 s44, s41, 9443584
    buffer_load_dwordx4 v11, s[28:31], s44 offen nt lds
    s_waitcnt vmcnt(25)
    s_mov_b32 m0, 8192
    s_add_u32 s44, s41, 512
    buffer_load_dwordx4 v10, s[28:31], s44 offen nt lds
    s_waitcnt vmcnt(25)
    s_mov_b32 m0, 9216
    s_add_u32 s44, s41, 512
    buffer_load_dwordx4 v11, s[28:31], s44 offen nt lds
    s_waitcnt vmcnt(25)
    s_mov_b32 m0, 10240
    s_add_u32 s44, s41, 6656
    buffer_load_dwordx4 v10, s[28:31], s44 offen nt lds
    s_waitcnt vmcnt(25)
    s_mov_b32 m0, 11264
    s_add_u32 s44, s41, 6656
    buffer_load_dwordx4 v11, s[28:31], s44 offen nt lds
    s_waitcnt vmcnt(25)
    s_mov_b32 m0, 20480
    s_add_u32 s44, s41, 3146240
    buffer_load_dwordx4 v10, s[28:31], s44 offen nt lds
    s_waitcnt vmcnt(25)
    s_mov_b32 m0, 21504
    s_add_u32 s44, s41, 3146240
    buffer_load_dwordx4 v11, s[28:31], s44 offen nt lds
    s_waitcnt vmcnt(25)
    s_mov_b32 m0, 22528
    s_add_u32 s44, s41, 3152384
    buffer_load_dwordx4 v10, s[28:31], s44 offen nt lds
    s_waitcnt vmcnt(25)
    s_mov_b32 m0, 23552
    s_add_u32 s44, s41, 3152384
    buffer_load_dwordx4 v11, s[28:31], s44 offen nt lds
    s_waitcnt vmcnt(25)
    s_mov_b32 m0, 32768
    s_add_u32 s44, s41, 6291968
    buffer_load_dwordx4 v10, s[28:31], s44 offen nt lds
    s_waitcnt vmcnt(25)
    v_mov_b32 v6, 1
    ds_write_b32 v15, v6 offset:0
    s_mov_b32 m0, 33792
    s_add_u32 s44, s41, 6291968
    buffer_load_dwordx4 v11, s[28:31], s44 offen nt lds
    s_waitcnt vmcnt(25)
    s_mov_b32 m0, 34816
    s_add_u32 s44, s41, 6298112
    buffer_load_dwordx4 v10, s[28:31], s44 offen nt lds
    s_waitcnt vmcnt(25)
    s_mov_b32 m0, 35840
    s_add_u32 s44, s41, 6298112
    buffer_load_dwordx4 v11, s[28:31], s44 offen nt lds
    s_waitcnt vmcnt(25)
    s_mov_b32 m0, 45056
    s_add_u32 s44, s41, 9437696
    buffer_load_dwordx4 v10, s[28:31], s44 offen nt lds
    s_waitcnt vmcnt(25)
    s_mov_b32 m0, 46080
    s_add_u32 s44, s41, 9437696
    buffer_load_dwordx4 v11, s[28:31], s44 offen nt lds
    s_waitcnt vmcnt(25)
    s_mov_b32 m0, 47104
    s_add_u32 s44, s41, 9443840
    buffer_load_dwordx4 v10, s[28:31], s44 offen nt lds
    s_waitcnt vmcnt(25)
    s_mov_b32 m0, 48128
    s_add_u32 s44, s41, 9443840
    buffer_load_dwordx4 v11, s[28:31], s44 offen nt lds
    s_waitcnt vmcnt(25)
    s_mov_b32 m0, 49152
    s_add_u32 s44, s40, 0
    buffer_load_dwordx4 v12, s[24:27], s44 offen nt lds
    s_waitcnt vmcnt(25)
    s_mov_b32 m0, 50176
    s_add_u32 s44, s40, 0
    buffer_load_dwordx4 v13, s[24:27], s44 offen nt lds
    s_waitcnt vmcnt(25)
    s_mov_b32 m0, 51200
    s_add_u32 s44, s40, 12288
    buffer_load_dwordx4 v12, s[24:27], s44 offen nt lds
    s_waitcnt vmcnt(25)
    s_mov_b32 m0, 52224
    s_add_u32 s44, s40, 12288
    buffer_load_dwordx4 v13, s[24:27], s44 offen nt lds
    s_waitcnt vmcnt(25)
    s_mov_b32 m0, 61440
    s_add_u32 s44, s40, 12582912
    buffer_load_dwordx4 v12, s[24:27], s44 offen nt lds
    s_waitcnt vmcnt(25)
    s_mov_b32 m0, 62464
    s_add_u32 s44, s40, 12582912
    buffer_load_dwordx4 v13, s[24:27], s44 offen nt lds
    s_waitcnt vmcnt(25)
    s_mov_b32 m0, 63488
    s_add_u32 s44, s40, 12595200
    buffer_load_dwordx4 v12, s[24:27], s44 offen nt lds
    s_waitcnt vmcnt(25)
    s_mov_b32 m0, 64512
    s_add_u32 s44, s40, 12595200
    buffer_load_dwordx4 v13, s[24:27], s44 offen nt lds
    s_waitcnt vmcnt(25)
    s_mov_b32 m0, 73728
    s_add_u32 s44, s40, 25165824
    buffer_load_dwordx4 v12, s[24:27], s44 offen nt lds
    s_waitcnt vmcnt(25)
    v_mov_b32 v6, 2
    ds_write_b32 v15, v6 offset:0
    s_mov_b32 m0, 74752
    s_add_u32 s44, s40, 25165824
    buffer_load_dwordx4 v13, s[24:27], s44 offen nt lds
    s_waitcnt vmcnt(25)
    s_mov_b32 m0, 75776
    s_add_u32 s44, s40, 25178112
    buffer_load_dwordx4 v12, s[24:27], s44 offen nt lds
    s_waitcnt vmcnt(25)
    s_mov_b32 m0, 76800
    s_add_u32 s44, s40, 25178112
    buffer_load_dwordx4 v13, s[24:27], s44 offen nt lds
    s_waitcnt vmcnt(25)
    s_mov_b32 m0, 86016
    s_add_u32 s44, s40, 37748736
    buffer_load_dwordx4 v12, s[24:27], s44 offen nt lds
    s_waitcnt vmcnt(25)
    s_mov_b32 m0, 87040
    s_add_u32 s44, s40, 37748736
    buffer_load_dwordx4 v13, s[24:27], s44 offen nt lds
    s_waitcnt vmcnt(25)
    s_mov_b32 m0, 88064
    s_add_u32 s44, s40, 37761024
    buffer_load_dwordx4 v12, s[24:27], s44 offen nt lds
    s_waitcnt vmcnt(25)
    s_mov_b32 m0, 89088
    s_add_u32 s44, s40, 37761024
    buffer_load_dwordx4 v13, s[24:27], s44 offen nt lds
    s_waitcnt vmcnt(25)
    s_mov_b32 m0, 53248
    s_add_u32 s44, s40, 256
    buffer_load_dwordx4 v12, s[24:27], s44 offen nt lds
    s_waitcnt vmcnt(25)
    s_mov_b32 m0, 54272
    s_add_u32 s44, s40, 256
    buffer_load_dwordx4 v13, s[24:27], s44 offen nt lds
    s_waitcnt vmcnt(25)
    s_mov_b32 m0, 55296
    s_add_u32 s44, s40, 12544
    buffer_load_dwordx4 v12, s[24:27], s44 offen nt lds
    s_waitcnt vmcnt(25)
    s_mov_b32 m0, 56320
    s_add_u32 s44, s40, 12544
    buffer_load_dwordx4 v13, s[24:27], s44 offen nt lds
    s_waitcnt vmcnt(25)
    s_mov_b32 m0, 65536
    s_add_u32 s44, s40, 12583168
    buffer_load_dwordx4 v12, s[24:27], s44 offen nt lds
    s_waitcnt vmcnt(25)
    s_mov_b32 m0, 66560
    s_add_u32 s44, s40, 12583168
    buffer_load_dwordx4 v13, s[24:27], s44 offen nt lds
    s_waitcnt vmcnt(25)
    s_mov_b32 m0, 67584
    s_add_u32 s44, s40, 12595456
    buffer_load_dwordx4 v12, s[24:27], s44 offen nt lds
    s_waitcnt vmcnt(25)
    s_mov_b32 m0, 68608
    s_add_u32 s44, s40, 12595456
    buffer_load_dwordx4 v13, s[24:27], s44 offen nt lds
    s_waitcnt vmcnt(25)
    s_mov_b32 m0, 77824
    s_add_u32 s44, s40, 25166080
    buffer_load_dwordx4 v12, s[24:27], s44 offen nt lds
    s_waitcnt vmcnt(25)
    v_mov_b32 v6, 3
    ds_write_b32 v15, v6 offset:0
    s_mov_b32 m0, 78848
    s_add_u32 s44, s40, 25166080
    buffer_load_dwordx4 v13, s[24:27], s44 offen nt lds
    s_waitcnt vmcnt(25)
    s_mov_b32 m0, 79872
    s_add_u32 s44, s40, 25178368
    buffer_load_dwordx4 v12, s[24:27], s44 offen nt lds
    s_waitcnt vmcnt(25)
    s_mov_b32 m0, 80896
    s_add_u32 s44, s40, 25178368
    buffer_load_dwordx4 v13, s[24:27], s44 offen nt lds
    s_waitcnt vmcnt(25)
    s_mov_b32 m0, 90112
    s_add_u32 s44, s40, 37748992
    buffer_load_dwordx4 v12, s[24:27], s44 offen nt lds
    s_waitcnt vmcnt(25)
    s_mov_b32 m0, 91136
    s_add_u32 s44, s40, 37748992
    buffer_load_dwordx4 v13, s[24:27], s44 offen nt lds
    s_waitcnt vmcnt(25)
    s_mov_b32 m0, 92160
    s_add_u32 s44, s40, 37761280
    buffer_load_dwordx4 v12, s[24:27], s44 offen nt lds
    s_waitcnt vmcnt(25)
    s_mov_b32 m0, 93184
    s_add_u32 s44, s40, 37761280
    buffer_load_dwordx4 v13, s[24:27], s44 offen nt lds
    s_waitcnt vmcnt(25)
    s_mov_b32 m0, 57344
    s_add_u32 s44, s40, 512
    buffer_load_dwordx4 v12, s[24:27], s44 offen nt lds
    s_waitcnt vmcnt(25)
    s_mov_b32 m0, 58368
    s_add_u32 s44, s40, 512
    buffer_load_dwordx4 v13, s[24:27], s44 offen nt lds
    s_waitcnt vmcnt(25)
    s_mov_b32 m0, 59392
    s_add_u32 s44, s40, 12800
    buffer_load_dwordx4 v12, s[24:27], s44 offen nt lds
    s_waitcnt vmcnt(25)
    s_mov_b32 m0, 60416
    s_add_u32 s44, s40, 12800
    buffer_load_dwordx4 v13, s[24:27], s44 offen nt lds
    s_waitcnt vmcnt(25)
    s_mov_b32 m0, 69632
    s_add_u32 s44, s40, 12583424
    buffer_load_dwordx4 v12, s[24:27], s44 offen nt lds
    s_waitcnt vmcnt(25)
    s_mov_b32 m0, 70656
    s_add_u32 s44, s40, 12583424
    buffer_load_dwordx4 v13, s[24:27], s44 offen nt lds
    s_waitcnt vmcnt(25)
    s_mov_b32 m0, 71680
    s_add_u32 s44, s40, 12595712
    buffer_load_dwordx4 v12, s[24:27], s44 offen nt lds
    s_waitcnt vmcnt(25)
    s_mov_b32 m0, 72704
    s_add_u32 s44, s40, 12595712
    buffer_load_dwordx4 v13, s[24:27], s44 offen nt lds
    s_waitcnt vmcnt(25)
    s_mov_b32 m0, 81920
    s_add_u32 s44, s40, 25166336
    buffer_load_dwordx4 v12, s[24:27], s44 offen nt lds
    s_waitcnt vmcnt(25)
    v_mov_b32 v6, 4
    ds_write_b32 v15, v6 offset:0
    s_mov_b32 m0, 82944
    s_add_u32 s44, s40, 25166336
    buffer_load_dwordx4 v13, s[24:27], s44 offen nt lds
    s_waitcnt vmcnt(25)
    s_mov_b32 m0, 83968
    s_add_u32 s44, s40, 25178624
    buffer_load_dwordx4 v12, s[24:27], s44 offen nt lds
    s_waitcnt vmcnt(25)
    s_mov_b32 m0, 84992
    s_add_u32 s44, s40, 25178624
    buffer_load_dwordx4 v13, s[24:27], s44 offen nt lds
    s_waitcnt vmcnt(25)
    s_mov_b32 m0, 94208
    s_add_u32 s44, s40, 37749248
    buffer_load_dwordx4 v12, s[24:27], s44 offen nt lds
    s_waitcnt vmcnt(25)
    s_mov_b32 m0, 95232
    s_add_u32 s44, s40, 37749248
    buffer_load_dwordx4 v13, s[24:27], s44 offen nt lds
    s_waitcnt vmcnt(25)
    s_mov_b32 m0, 96256
    s_add_u32 s44, s40, 37761536
    buffer_load_dwordx4 v12, s[24:27], s44 offen nt lds
    s_waitcnt vmcnt(25)
    s_mov_b32 m0, 97280
    s_add_u32 s44, s40, 37761536
    buffer_load_dwordx4 v13, s[24:27], s44 offen nt lds
L_spin_181:
    ds_read_b128 v[16:19], v15 offset:64
    s_waitcnt lgkmcnt(0)
    v_min3_u32 v16, v16, v17, v18
    v_min_u32 v16, v16, v19
    s_nop 0
    v_readfirstlane_b32 s61, v16
    s_nop 0
    s_cmp_ge_u32 s61, 1
    s_cbranch_scc0 L_retry_183
L_done_182:
    s_waitcnt vmcnt(25)
    s_mov_b32 m0, 98304
    s_add_u32 s44, s40, 768
    buffer_load_dwordx4 v12, s[24:27], s44 offen nt lds
    s_waitcnt vmcnt(25)
    s_mov_b32 m0, 99328
    s_add_u32 s44, s40, 768
    buffer_load_dwordx4 v13, s[24:27], s44 offen nt lds
    s_waitcnt vmcnt(25)
    s_mov_b32 m0, 100352
    s_add_u32 s44, s40, 13056
    buffer_load_dwordx4 v12, s[24:27], s44 offen nt lds
    s_waitcnt vmcnt(25)
    s_mov_b32 m0, 101376
    s_add_u32 s44, s40, 13056
    buffer_load_dwordx4 v13, s[24:27], s44 offen nt lds
    s_waitcnt vmcnt(25)
    s_mov_b32 m0, 110592
    s_add_u32 s44, s40, 12583680
    buffer_load_dwordx4 v12, s[24:27], s44 offen nt lds
    s_waitcnt vmcnt(25)
    s_mov_b32 m0, 111616
    s_add_u32 s44, s40, 12583680
    buffer_load_dwordx4 v13, s[24:27], s44 offen nt lds
    s_waitcnt vmcnt(25)
    s_mov_b32 m0, 112640
    s_add_u32 s44, s40, 12595968
    buffer_load_dwordx4 v12, s[24:27], s44 offen nt lds
    s_waitcnt vmcnt(25)
    s_mov_b32 m0, 113664
    s_add_u32 s44, s40, 12595968
    buffer_load_dwordx4 v13, s[24:27], s44 offen nt lds
    s_waitcnt vmcnt(25)
    s_mov_b32 m0, 122880
    s_add_u32 s44, s40, 25166592
    buffer_load_dwordx4 v12, s[24:27], s44 offen nt lds
    s_waitcnt vmcnt(25)
    v_mov_b32 v6, 5
    ds_write_b32 v15, v6 offset:0
    s_mov_b32 m0, 123904
    s_add_u32 s44, s40, 25166592
    buffer_load_dwordx4 v13, s[24:27], s44 offen nt lds
    s_waitcnt vmcnt(25)
    s_mov_b32 m0, 124928
    s_add_u32 s44, s40, 25178880
    buffer_load_dwordx4 v12, s[24:27], s44 offen nt lds
    s_waitcnt vmcnt(25)
    s_mov_b32 m0, 125952
    s_add_u32 s44, s40, 25178880
    buffer_load_dwordx4 v13, s[24:27], s44 offen nt lds
    s_waitcnt vmcnt(25)
    s_mov_b32 m0, 135168
    s_add_u32 s44, s40, 37749504
    buffer_load_dwordx4 v12, s[24:27], s44 offen nt lds
    s_waitcnt vmcnt(25)
    s_mov_b32 m0, 136192
    s_add_u32 s44, s40, 37749504
    buffer_load_dwordx4 v13, s[24:27], s44 offen nt lds
    s_waitcnt vmcnt(25)
    s_mov_b32 m0, 137216
    s_add_u32 s44, s40, 37761792
    buffer_load_dwordx4 v12, s[24:27], s44 offen nt lds
    s_waitcnt vmcnt(25)
    s_mov_b32 m0, 138240
    s_add_u32 s44, s40, 37761792
    buffer_load_dwordx4 v13, s[24:27], s44 offen nt lds
    s_waitcnt vmcnt(25)
    s_mov_b32 m0, 102400
    s_add_u32 s44, s40, 1024
    buffer_load_dwordx4 v12, s[24:27], s44 offen nt lds
    s_waitcnt vmcnt(25)
    s_mov_b32 m0, 103424
    s_add_u32 s44, s40, 1024
    buffer_load_dwordx4 v13, s[24:27], s44 offen nt lds
    s_waitcnt vmcnt(25)
    s_mov_b32 m0, 104448
    s_add_u32 s44, s40, 13312
    buffer_load_dwordx4 v12, s[24:27], s44 offen nt lds
    s_waitcnt vmcnt(25)
    s_mov_b32 m0, 105472
    s_add_u32 s44, s40, 13312
    buffer_load_dwordx4 v13, s[24:27], s44 offen nt lds
    s_waitcnt vmcnt(25)
    s_mov_b32 m0, 114688
    s_add_u32 s44, s40, 12583936
    buffer_load_dwordx4 v12, s[24:27], s44 offen nt lds
    s_waitcnt vmcnt(25)
    s_mov_b32 m0, 115712
    s_add_u32 s44, s40, 12583936
    buffer_load_dwordx4 v13, s[24:27], s44 offen nt lds
    s_waitcnt vmcnt(25)
    s_mov_b32 m0, 116736
    s_add_u32 s44, s40, 12596224
    buffer_load_dwordx4 v12, s[24:27], s44 offen nt lds
    s_waitcnt vmcnt(25)
    s_mov_b32 m0, 117760
    s_add_u32 s44, s40, 12596224
    buffer_load_dwordx4 v13, s[24:27], s44 offen nt lds
    s_waitcnt vmcnt(25)
    s_mov_b32 m0, 126976
    s_add_u32 s44, s40, 25166848
    buffer_load_dwordx4 v12, s[24:27], s44 offen nt lds
    s_waitcnt vmcnt(25)
    v_mov_b32 v6, 6
    ds_write_b32 v15, v6 offset:0
    s_mov_b32 m0, 128000
    s_add_u32 s44, s40, 25166848
    buffer_load_dwordx4 v13, s[24:27], s44 offen nt lds
    s_waitcnt vmcnt(25)
    s_mov_b32 m0, 129024
    s_add_u32 s44, s40, 25179136
    buffer_load_dwordx4 v12, s[24:27], s44 offen nt lds
    s_waitcnt vmcnt(25)
    s_mov_b32 m0, 130048
    s_add_u32 s44, s40, 25179136
    buffer_load_dwordx4 v13, s[24:27], s44 offen nt lds
    s_waitcnt vmcnt(25)
    s_mov_b32 m0, 139264
    s_add_u32 s44, s40, 37749760
    buffer_load_dwordx4 v12, s[24:27], s44 offen nt lds
    s_waitcnt vmcnt(25)
    s_mov_b32 m0, 140288
    s_add_u32 s44, s40, 37749760
    buffer_load_dwordx4 v13, s[24:27], s44 offen nt lds
    s_waitcnt vmcnt(25)
    s_mov_b32 m0, 141312
    s_add_u32 s44, s40, 37762048
    buffer_load_dwordx4 v12, s[24:27], s44 offen nt lds
    s_waitcnt vmcnt(25)
    s_mov_b32 m0, 142336
    s_add_u32 s44, s40, 37762048
    buffer_load_dwordx4 v13, s[24:27], s44 offen nt lds
    s_waitcnt vmcnt(25)
    s_mov_b32 m0, 106496
    s_add_u32 s44, s40, 1280
    buffer_load_dwordx4 v12, s[24:27], s44 offen nt lds
    s_waitcnt vmcnt(25)
    s_mov_b32 m0, 107520
    s_add_u32 s44, s40, 1280
    buffer_load_dwordx4 v13, s[24:27], s44 offen nt lds
    s_waitcnt vmcnt(25)
    s_mov_b32 m0, 108544
    s_add_u32 s44, s40, 13568
    buffer_load_dwordx4 v12, s[24:27], s44 offen nt lds
    s_waitcnt vmcnt(25)
    s_mov_b32 m0, 109568
    s_add_u32 s44, s40, 13568
    buffer_load_dwordx4 v13, s[24:27], s44 offen nt lds
    s_waitcnt vmcnt(25)
    s_mov_b32 m0, 118784
    s_add_u32 s44, s40, 12584192
    buffer_load_dwordx4 v12, s[24:27], s44 offen nt lds
    s_waitcnt vmcnt(25)
    s_mov_b32 m0, 119808
    s_add_u32 s44, s40, 12584192
    buffer_load_dwordx4 v13, s[24:27], s44 offen nt lds
    s_waitcnt vmcnt(25)
    s_mov_b32 m0, 120832
    s_add_u32 s44, s40, 12596480
    buffer_load_dwordx4 v12, s[24:27], s44 offen nt lds
    s_waitcnt vmcnt(25)
    s_mov_b32 m0, 121856
    s_add_u32 s44, s40, 12596480
    buffer_load_dwordx4 v13, s[24:27], s44 offen nt lds
    s_waitcnt vmcnt(25)
    s_mov_b32 m0, 131072
    s_add_u32 s44, s40, 25167104
    buffer_load_dwordx4 v12, s[24:27], s44 offen nt lds
    s_waitcnt vmcnt(25)
    v_mov_b32 v6, 7
    ds_write_b32 v15, v6 offset:0
    s_mov_b32 m0, 132096
    s_add_u32 s44, s40, 25167104
    buffer_load_dwordx4 v13, s[24:27], s44 offen nt lds
    s_waitcnt vmcnt(25)
    s_mov_b32 m0, 133120
    s_add_u32 s44, s40, 25179392
    buffer_load_dwordx4 v12, s[24:27], s44 offen nt lds
    s_waitcnt vmcnt(25)
    s_mov_b32 m0, 134144
    s_add_u32 s44, s40, 25179392
    buffer_load_dwordx4 v13, s[24:27], s44 offen nt lds
    s_waitcnt vmcnt(25)
    s_mov_b32 m0, 143360
    s_add_u32 s44, s40, 37750016
    buffer_load_dwordx4 v12, s[24:27], s44 offen nt lds
    s_waitcnt vmcnt(25)
    s_mov_b32 m0, 144384
    s_add_u32 s44, s40, 37750016
    buffer_load_dwordx4 v13, s[24:27], s44 offen nt lds
    s_waitcnt vmcnt(25)
    s_mov_b32 m0, 145408
    s_add_u32 s44, s40, 37762304
    buffer_load_dwordx4 v12, s[24:27], s44 offen nt lds
    s_waitcnt vmcnt(25)
    s_mov_b32 m0, 146432
    s_add_u32 s44, s40, 37762304
    buffer_load_dwordx4 v13, s[24:27], s44 offen nt lds
    v_mov_b32 v6, 1
    ds_write_b32 v15, v6 offset:12
    s_waitcnt vmcnt(16)
    v_mov_b32 v6, 8
    ds_write_b32 v15, v6 offset:0
    s_waitcnt vmcnt(0)
    v_mov_b32 v6, 9
    ds_write_b32 v15, v6 offset:0
L_spin_184:
    ds_read_b64 v[16:17], v15 offset:248
    s_waitcnt lgkmcnt(0)
    v_min_u32 v16, v16, v17
    s_nop 0
    v_readfirstlane_b32 s61, v16
    s_nop 0
    s_cmp_ge_u32 s61, 1
    s_cbranch_scc0 L_retry_186
L_done_185:
L_spin_187:
    ds_read_b128 v[16:19], v15 offset:16
    s_waitcnt lgkmcnt(0)
    v_min3_u32 v16, v16, v17, v18
    v_min_u32 v16, v16, v19
    s_nop 0
    v_readfirstlane_b32 s61, v16
    s_nop 0
    s_cmp_ge_u32 s61, 1
    s_cbranch_scc0 L_retry_189
L_done_188:
L_spin_190:
    ds_read_b64 v[16:17], v15 offset:272
    s_waitcnt lgkmcnt(0)
    v_min_u32 v16, v16, v17
    s_nop 0
    v_readfirstlane_b32 s61, v16
    s_nop 0
    s_cmp_ge_u32 s61, 1
    s_cbranch_scc0 L_retry_192
L_done_191:
    ds_read_b32 v16, v15 offset:4
    s_waitcnt lgkmcnt(0)
    v_readfirstlane_b32 s61, v16
    s_nop 0
    s_cmp_eq_u32 s61, 0
    s_cbranch_scc1 L_shal_193
    s_mov_b32 m0, 0
    s_add_u32 s44, s40, 197376
    buffer_load_dwordx4 v12, s[24:27], s44 offen nt lds
    s_mov_b32 m0, 1024
    s_add_u32 s44, s40, 197376
    buffer_load_dwordx4 v13, s[24:27], s44 offen nt lds
    s_mov_b32 m0, 2048
    s_add_u32 s44, s40, 209664
    buffer_load_dwordx4 v12, s[24:27], s44 offen nt lds
    s_mov_b32 m0, 3072
    s_add_u32 s44, s40, 209664
    buffer_load_dwordx4 v13, s[24:27], s44 offen nt lds
    s_mov_b32 m0, 12288
    s_add_u32 s44, s40, 12780288
    buffer_load_dwordx4 v12, s[24:27], s44 offen nt lds
    s_mov_b32 m0, 13312
    s_add_u32 s44, s40, 12780288
    buffer_load_dwordx4 v13, s[24:27], s44 offen nt lds
    s_mov_b32 m0, 14336
    s_add_u32 s44, s40, 12792576
    buffer_load_dwordx4 v12, s[24:27], s44 offen nt lds
    s_mov_b32 m0, 15360
    s_add_u32 s44, s40, 12792576
    buffer_load_dwordx4 v13, s[24:27], s44 offen nt lds
    s_mov_b32 m0, 24576
    s_add_u32 s44, s40, 25363200
    buffer_load_dwordx4 v12, s[24:27], s44 offen nt lds
    s_mov_b32 m0, 25600
    s_add_u32 s44, s40, 25363200
    buffer_load_dwordx4 v13, s[24:27], s44 offen nt lds
    s_mov_b32 m0, 26624
    s_add_u32 s44, s40, 25375488
    buffer_load_dwordx4 v12, s[24:27], s44 offen nt lds
    s_mov_b32 m0, 27648
    s_add_u32 s44, s40, 25375488
    buffer_load_dwordx4 v13, s[24:27], s44 offen nt lds
    s_mov_b32 m0, 36864
    s_add_u32 s44, s40, 37946112
    buffer_load_dwordx4 v12, s[24:27], s44 offen nt lds
    s_mov_b32 m0, 37888
    s_add_u32 s44, s40, 37946112
    buffer_load_dwordx4 v13, s[24:27], s44 offen nt lds
    s_mov_b32 m0, 38912
    s_add_u32 s44, s40, 37958400
    buffer_load_dwordx4 v12, s[24:27], s44 offen nt lds
    s_mov_b32 m0, 39936
    s_add_u32 s44, s40, 37958400
    buffer_load_dwordx4 v13, s[24:27], s44 offen nt lds
    s_mov_b32 m0, 4096
    s_add_u32 s44, s40, 197632
    buffer_load_dwordx4 v12, s[24:27], s44 offen nt lds
    s_mov_b32 m0, 5120
    s_add_u32 s44, s40, 197632
    buffer_load_dwordx4 v13, s[24:27], s44 offen nt lds
    s_mov_b32 m0, 6144
    s_add_u32 s44, s40, 209920
    buffer_load_dwordx4 v12, s[24:27], s44 offen nt lds
    s_mov_b32 m0, 7168
    s_add_u32 s44, s40, 209920
    buffer_load_dwordx4 v13, s[24:27], s44 offen nt lds
    s_mov_b32 m0, 16384
    s_add_u32 s44, s40, 12780544
    buffer_load_dwordx4 v12, s[24:27], s44 offen nt lds
    s_mov_b32 m0, 17408
    s_add_u32 s44, s40, 12780544
    buffer_load_dwordx4 v13, s[24:27], s44 offen nt lds
    s_mov_b32 m0, 18432
    s_add_u32 s44, s40, 12792832
    buffer_load_dwordx4 v12, s[24:27], s44 offen nt lds
    s_mov_b32 m0, 19456
    s_add_u32 s44, s40, 12792832
    buffer_load_dwordx4 v13, s[24:27], s44 offen nt lds
    s_mov_b32 m0, 28672
    s_add_u32 s44, s40, 25363456
    buffer_load_dwordx4 v12, s[24:27], s44 offen nt lds
    s_mov_b32 m0, 29696
    s_add_u32 s44, s40, 25363456
    buffer_load_dwordx4 v13, s[24:27], s44 offen nt lds
    s_mov_b32 m0, 30720
    s_add_u32 s44, s40, 25375744
    buffer_load_dwordx4 v12, s[24:27], s44 offen nt lds
    s_mov_b32 m0, 31744
    s_add_u32 s44, s40, 25375744
    buffer_load_dwordx4 v13, s[24:27], s44 offen nt lds
    s_mov_b32 m0, 40960
    s_add_u32 s44, s40, 37946368
    buffer_load_dwordx4 v12, s[24:27], s44 offen nt lds
    s_mov_b32 m0, 41984
    s_add_u32 s44, s40, 37946368
    buffer_load_dwordx4 v13, s[24:27], s44 offen nt lds
    s_mov_b32 m0, 43008
    s_add_u32 s44, s40, 37958656
    buffer_load_dwordx4 v12, s[24:27], s44 offen nt lds
    s_mov_b32 m0, 44032
    s_add_u32 s44, s40, 37958656
    buffer_load_dwordx4 v13, s[24:27], s44 offen nt lds
    s_mov_b32 m0, 8192
    s_add_u32 s44, s40, 197888
    buffer_load_dwordx4 v12, s[24:27], s44 offen nt lds
    s_mov_b32 m0, 9216
    s_add_u32 s44, s40, 197888
    buffer_load_dwordx4 v13, s[24:27], s44 offen nt lds
    s_waitcnt vmcnt(33)
    s_mov_b32 m0, 10240
    s_add_u32 s44, s40, 210176
    buffer_load_dwordx4 v12, s[24:27], s44 offen nt lds
    s_waitcnt vmcnt(33)
    s_mov_b32 m0, 11264
    s_add_u32 s44, s40, 210176
    buffer_load_dwordx4 v13, s[24:27], s44 offen nt lds
    s_waitcnt vmcnt(33)
    s_mov_b32 m0, 20480
    s_add_u32 s44, s40, 12780800
    buffer_load_dwordx4 v12, s[24:27], s44 offen nt lds
    s_waitcnt vmcnt(33)
    s_mov_b32 m0, 21504
    s_add_u32 s44, s40, 12780800
    buffer_load_dwordx4 v13, s[24:27], s44 offen nt lds
    s_waitcnt vmcnt(33)
    s_mov_b32 m0, 22528
    s_add_u32 s44, s40, 12793088
    buffer_load_dwordx4 v12, s[24:27], s44 offen nt lds
    s_waitcnt vmcnt(33)
    s_mov_b32 m0, 23552
    s_add_u32 s44, s40, 12793088
    buffer_load_dwordx4 v13, s[24:27], s44 offen nt lds
    s_waitcnt vmcnt(33)
    s_mov_b32 m0, 32768
    s_add_u32 s44, s40, 25363712
    buffer_load_dwordx4 v12, s[24:27], s44 offen nt lds
    s_waitcnt vmcnt(33)
    s_mov_b32 m0, 33792
    s_add_u32 s44, s40, 25363712
    buffer_load_dwordx4 v13, s[24:27], s44 offen nt lds
    s_waitcnt vmcnt(33)
    s_mov_b32 m0, 34816
    s_add_u32 s44, s40, 25376000
    buffer_load_dwordx4 v12, s[24:27], s44 offen nt lds
    s_waitcnt vmcnt(33)
    s_mov_b32 m0, 35840
    s_add_u32 s44, s40, 25376000
    buffer_load_dwordx4 v13, s[24:27], s44 offen nt lds
    s_waitcnt vmcnt(33)
    s_mov_b32 m0, 45056
    s_add_u32 s44, s40, 37946624
    buffer_load_dwordx4 v12, s[24:27], s44 offen nt lds
    s_waitcnt vmcnt(33)
    s_mov_b32 m0, 46080
    s_add_u32 s44, s40, 37946624
    buffer_load_dwordx4 v13, s[24:27], s44 offen nt lds
    s_waitcnt vmcnt(33)
    s_mov_b32 m0, 47104
    s_add_u32 s44, s40, 37958912
    buffer_load_dwordx4 v12, s[24:27], s44 offen nt lds
    s_waitcnt vmcnt(33)
    s_mov_b32 m0, 48128
    s_add_u32 s44, s40, 37958912
    buffer_load_dwordx4 v13, s[24:27], s44 offen nt lds
    s_waitcnt vmcnt(32)
    v_mov_b32 v6, 10
    ds_write_b32 v15, v6 offset:0
    s_waitcnt vmcnt(16)
    v_mov_b32 v6, 11
    ds_write_b32 v15, v6 offset:0
    s_waitcnt vmcnt(0)
    v_mov_b32 v6, 12
    ds_write_b32 v15, v6 offset:0
    s_branch L_lfin_194
L_shal_193:
    s_mov_b32 m0, 0
    s_add_u32 s44, s40, 197376
    buffer_load_dwordx4 v12, s[24:27], s44 offen nt lds
    s_mov_b32 m0, 1024
    s_add_u32 s44, s40, 197376
    buffer_load_dwordx4 v13, s[24:27], s44 offen nt lds
    s_mov_b32 m0, 2048
    s_add_u32 s44, s40, 209664
    buffer_load_dwordx4 v12, s[24:27], s44 offen nt lds
    s_mov_b32 m0, 3072
    s_add_u32 s44, s40, 209664
    buffer_load_dwordx4 v13, s[24:27], s44 offen nt lds
    s_mov_b32 m0, 12288
    s_add_u32 s44, s40, 12780288
    buffer_load_dwordx4 v12, s[24:27], s44 offen nt lds
    s_mov_b32 m0, 13312
    s_add_u32 s44, s40, 12780288
    buffer_load_dwordx4 v13, s[24:27], s44 offen nt lds
    s_mov_b32 m0, 14336
    s_add_u32 s44, s40, 12792576
    buffer_load_dwordx4 v12, s[24:27], s44 offen nt lds
    s_mov_b32 m0, 15360
    s_add_u32 s44, s40, 12792576
    buffer_load_dwordx4 v13, s[24:27], s44 offen nt lds
    s_mov_b32 m0, 24576
    s_add_u32 s44, s40, 25363200
    buffer_load_dwordx4 v12, s[24:27], s44 offen nt lds
    s_mov_b32 m0, 25600
    s_add_u32 s44, s40, 25363200
    buffer_load_dwordx4 v13, s[24:27], s44 offen nt lds
    s_mov_b32 m0, 26624
    s_add_u32 s44, s40, 25375488
    buffer_load_dwordx4 v12, s[24:27], s44 offen nt lds
    s_mov_b32 m0, 27648
    s_add_u32 s44, s40, 25375488
    buffer_load_dwordx4 v13, s[24:27], s44 offen nt lds
    s_mov_b32 m0, 36864
    s_add_u32 s44, s40, 37946112
    buffer_load_dwordx4 v12, s[24:27], s44 offen nt lds
    s_mov_b32 m0, 37888
    s_add_u32 s44, s40, 37946112
    buffer_load_dwordx4 v13, s[24:27], s44 offen nt lds
    s_mov_b32 m0, 38912
    s_add_u32 s44, s40, 37958400
    buffer_load_dwordx4 v12, s[24:27], s44 offen nt lds
    s_mov_b32 m0, 39936
    s_add_u32 s44, s40, 37958400
    buffer_load_dwordx4 v13, s[24:27], s44 offen nt lds
    s_mov_b32 m0, 4096
    s_add_u32 s44, s40, 197632
    buffer_load_dwordx4 v12, s[24:27], s44 offen nt lds
    s_mov_b32 m0, 5120
    s_add_u32 s44, s40, 197632
    buffer_load_dwordx4 v13, s[24:27], s44 offen nt lds
    s_mov_b32 m0, 6144
    s_add_u32 s44, s40, 209920
    buffer_load_dwordx4 v12, s[24:27], s44 offen nt lds
    s_mov_b32 m0, 7168
    s_add_u32 s44, s40, 209920
    buffer_load_dwordx4 v13, s[24:27], s44 offen nt lds
    s_mov_b32 m0, 16384
    s_add_u32 s44, s40, 12780544
    buffer_load_dwordx4 v12, s[24:27], s44 offen nt lds
    s_mov_b32 m0, 17408
    s_add_u32 s44, s40, 12780544
    buffer_load_dwordx4 v13, s[24:27], s44 offen nt lds
    s_mov_b32 m0, 18432
    s_add_u32 s44, s40, 12792832
    buffer_load_dwordx4 v12, s[24:27], s44 offen nt lds
    s_mov_b32 m0, 19456
    s_add_u32 s44, s40, 12792832
    buffer_load_dwordx4 v13, s[24:27], s44 offen nt lds
    s_mov_b32 m0, 28672
    s_add_u32 s44, s40, 25363456
    buffer_load_dwordx4 v12, s[24:27], s44 offen nt lds
    s_mov_b32 m0, 29696
    s_add_u32 s44, s40, 25363456
    buffer_load_dwordx4 v13, s[24:27], s44 offen nt lds
    s_mov_b32 m0, 30720
    s_add_u32 s44, s40, 25375744
    buffer_load_dwordx4 v12, s[24:27], s44 offen nt lds
    s_mov_b32 m0, 31744
    s_add_u32 s44, s40, 25375744
    buffer_load_dwordx4 v13, s[24:27], s44 offen nt lds
    s_mov_b32 m0, 40960
    s_add_u32 s44, s40, 37946368
    buffer_load_dwordx4 v12, s[24:27], s44 offen nt lds
    s_mov_b32 m0, 41984
    s_add_u32 s44, s40, 37946368
    buffer_load_dwordx4 v13, s[24:27], s44 offen nt lds
    s_waitcnt vmcnt(29)
    s_mov_b32 m0, 43008
    s_add_u32 s44, s40, 37958656
    buffer_load_dwordx4 v12, s[24:27], s44 offen nt lds
    s_waitcnt vmcnt(29)
    s_mov_b32 m0, 44032
    s_add_u32 s44, s40, 37958656
    buffer_load_dwordx4 v13, s[24:27], s44 offen nt lds
    s_waitcnt vmcnt(29)
    s_mov_b32 m0, 8192
    s_add_u32 s44, s40, 197888
    buffer_load_dwordx4 v12, s[24:27], s44 offen nt lds
    s_waitcnt vmcnt(29)
    s_mov_b32 m0, 9216
    s_add_u32 s44, s40, 197888
    buffer_load_dwordx4 v13, s[24:27], s44 offen nt lds
    s_waitcnt vmcnt(29)
    s_mov_b32 m0, 10240
    s_add_u32 s44, s40, 210176
    buffer_load_dwordx4 v12, s[24:27], s44 offen nt lds
    s_waitcnt vmcnt(29)
    s_mov_b32 m0, 11264
    s_add_u32 s44, s40, 210176
    buffer_load_dwordx4 v13, s[24:27], s44 offen nt lds
    s_waitcnt vmcnt(29)
    s_mov_b32 m0, 20480
    s_add_u32 s44, s40, 12780800
    buffer_load_dwordx4 v12, s[24:27], s44 offen nt lds
    s_waitcnt vmcnt(29)
    s_mov_b32 m0, 21504
    s_add_u32 s44, s40, 12780800
    buffer_load_dwordx4 v13, s[24:27], s44 offen nt lds
    s_waitcnt vmcnt(29)
    s_mov_b32 m0, 22528
    s_add_u32 s44, s40, 12793088
    buffer_load_dwordx4 v12, s[24:27], s44 offen nt lds
    s_waitcnt vmcnt(29)
    s_mov_b32 m0, 23552
    s_add_u32 s44, s40, 12793088
    buffer_load_dwordx4 v13, s[24:27], s44 offen nt lds
    s_waitcnt vmcnt(29)
    s_mov_b32 m0, 32768
    s_add_u32 s44, s40, 25363712
    buffer_load_dwordx4 v12, s[24:27], s44 offen nt lds
    s_waitcnt vmcnt(29)
    s_mov_b32 m0, 33792
    s_add_u32 s44, s40, 25363712
    buffer_load_dwordx4 v13, s[24:27], s44 offen nt lds
    s_waitcnt vmcnt(29)
    s_mov_b32 m0, 34816
    s_add_u32 s44, s40, 25376000
    buffer_load_dwordx4 v12, s[24:27], s44 offen nt lds
    s_waitcnt vmcnt(29)
    s_mov_b32 m0, 35840
    s_add_u32 s44, s40, 25376000
    buffer_load_dwordx4 v13, s[24:27], s44 offen nt lds
    s_waitcnt vmcnt(29)
    s_mov_b32 m0, 45056
    s_add_u32 s44, s40, 37946624
    buffer_load_dwordx4 v12, s[24:27], s44 offen nt lds
    s_waitcnt vmcnt(29)
    v_mov_b32 v6, 10
    ds_write_b32 v15, v6 offset:0
    s_mov_b32 m0, 46080
    s_add_u32 s44, s40, 37946624
    buffer_load_dwordx4 v13, s[24:27], s44 offen nt lds
    s_waitcnt vmcnt(29)
    s_mov_b32 m0, 47104
    s_add_u32 s44, s40, 37958912
    buffer_load_dwordx4 v12, s[24:27], s44 offen nt lds
    s_waitcnt vmcnt(29)
    s_mov_b32 m0, 48128
    s_add_u32 s44, s40, 37958912
    buffer_load_dwordx4 v13, s[24:27], s44 offen nt lds
    s_waitcnt vmcnt(16)
    v_mov_b32 v6, 11
    ds_write_b32 v15, v6 offset:0
    s_waitcnt vmcnt(0)
    v_mov_b32 v6, 12
    ds_write_b32 v15, v6 offset:0
L_lfin_194:
L_ldjoin_150:
    s_cmp_lt_u32 s2, 192
    s_cbranch_scc1 L_nofinal_195
    s_cmp_ge_u32 s2, 216
    s_cbranch_scc1 L_nofinal_195
    s_waitcnt lgkmcnt(0)
    s_add_u32 s54, s54, 1
    s_and_b32 s61, s54, 0xffff
    s_cmp_eq_u32 s61, 0
    s_addc_u32 s54, s54, 0
    s_mov_b32 s36, s4
    s_and_b32 s37, s5, 0xffff
    s_mov_b32 s38, 12288
    s_mov_b32 s39, 0x20000
    s_mov_b32 s56, s18
    s_and_b32 s57, s19, 0xffff
    s_mov_b32 s58, 12288
    s_mov_b32 s59, 0x20000
    s_sub_u32 s40, s2, 192
    s_lshl_b32 s41, s40, 7
    s_add_u32 s41, s41, 458752
    v_min_u32 v1, 23, v0
    v_lshlrev_b32 v1, 2, v1
L_pflg_196:
    buffer_load_dword v4, v1, s[32:35], s41 offen sc1
    s_waitcnt vmcnt(0)
    v_cmp_ne_u32 vcc, s54, v4
    s_nop 0
    s_cbranch_vccz L_pflgd_197
    s_sub_u32 s55, s55, 1
    s_cbranch_scc0 L_pflg_196
    s_mov_b32 s55, 0
L_pflgd_197:
    v_lshlrev_b32 v1, 4, v0
    v_lshlrev_b32 v3, 3, v0
    s_mul_i32 s41, s40, 12288
    s_add_u32 s41, s41, 65536
    buffer_load_dwordx2 v[164:165], v3, s[32:35], s41 offen offset:0 sc1
    buffer_load_dwordx2 v[166:167], v3, s[32:35], s41 offen offset:512 sc1
    buffer_load_dwordx2 v[168:169], v3, s[32:35], s41 offen offset:1024 sc1
    buffer_load_dwordx2 v[170:171], v3, s[32:35], s41 offen offset:1536 sc1
    buffer_load_dwordx2 v[172:173], v3, s[32:35], s41 offen offset:2048 sc1
    buffer_load_dwordx2 v[174:175], v3, s[32:35], s41 offen offset:2560 sc1
    buffer_load_dwordx2 v[176:177], v3, s[32:35], s41 offen offset:3072 sc1
    buffer_load_dwordx2 v[178:179], v3, s[32:35], s41 offen offset:3584 sc1
    s_add_u32 s41, s41, 4096
    buffer_load_dwordx2 v[180:181], v3, s[32:35], s41 offen offset:0 sc1
    buffer_load_dwordx2 v[182:183], v3, s[32:35], s41 offen offset:512 sc1
    buffer_load_dwordx2 v[184:185], v3, s[32:35], s41 offen offset:1024 sc1
    buffer_load_dwordx2 v[186:187], v3, s[32:35], s41 offen offset:1536 sc1
    buffer_load_dwordx2 v[188:189], v3, s[32:35], s41 offen offset:2048 sc1
    buffer_load_dwordx2 v[190:191], v3, s[32:35], s41 offen offset:2560 sc1
    buffer_load_dwordx2 v[192:193], v3, s[32:35], s41 offen offset:3072 sc1
    buffer_load_dwordx2 v[194:195], v3, s[32:35], s41 offen offset:3584 sc1
    s_add_u32 s41, s41, 4096
    buffer_load_dwordx2 v[196:197], v3, s[32:35], s41 offen offset:0 sc1
    buffer_load_dwordx2 v[198:199], v3, s[32:35], s41 offen offset:512 sc1
    buffer_load_dwordx2 v[200:201], v3, s[32:35], s41 offen offset:1024 sc1
    buffer_load_dwordx2 v[202:203], v3, s[32:35], s41 offen offset:1536 sc1
    buffer_load_dwordx2 v[204:205], v3, s[32:35], s41 offen offset:2048 sc1
    buffer_load_dwordx2 v[206:207], v3, s[32:35], s41 offen offset:2560 sc1
    buffer_load_dwordx2 v[208:209], v3, s[32:35], s41 offen offset:3072 sc1
    buffer_load_dwordx2 v[210:211], v3, s[32:35], s41 offen offset:3584 sc1
    v_and_b32 v2, 15, v0
    v_mul_u32_u24 v2, 768, v2
    v_lshrrev_b32 v3, 4, v0
    v_lshlrev_b32 v3, 3, v3
    v_add_u32 v2, v2, v3
    s_lshl_b32 s42, s40, 5
    buffer_load_dwordx2 v[144:145], v2, s[36:39], s42 offen
    v_mov_b32 v8, 0x3f803f80
    v_mov_b32 v9, 0x3f803f80
    v_mov_b32 v10, 0x3f803f80
    v_mov_b32 v11, 0x3f803f80
    v_mov_b32 v19, 0
    v_mov_b32 v23, 0
    v_mov_b32 v27, 0
    v_mov_b32 v31, 0
    v_mov_b32 v35, 0
    v_mov_b32 v39, 0
    v_mov_b32 v43, 0
    v_mov_b32 v47, 0
    v_mov_b32 v51, 0
    v_mov_b32 v55, 0
    v_mov_b32 v59, 0
    v_mov_b32 v63, 0
    v_mov_b32 v67, 0
    v_mov_b32 v71, 0
    v_mov_b32 v75, 0
    v_mov_b32 v79, 0
    s_waitcnt vmcnt(23)
    v_mfma_f32_16x16x32_bf16 v[152:155], v[8:11], v[164:167], 0
    s_waitcnt vmcnt(21)
    v_mfma_f32_16x16x32_bf16 v[152:155], v[8:11], v[168:171], v[152:155]
    s_waitcnt vmcnt(19)
    v_mfma_f32_16x16x32_bf16 v[152:155], v[8:11], v[172:175], v[152:155]
    s_waitcnt vmcnt(17)
    v_mfma_f32_16x16x32_bf16 v[152:155], v[8:11], v[176:179], v[152:155]
    s_waitcnt vmcnt(15)
    v_mfma_f32_16x16x32_bf16 v[152:155], v[8:11], v[180:183], v[152:155]
    s_waitcnt vmcnt(13)
    v_mfma_f32_16x16x32_bf16 v[152:155], v[8:11], v[184:187], v[152:155]
    s_waitcnt vmcnt(11)
    v_mfma_f32_16x16x32_bf16 v[152:155], v[8:11], v[188:191], v[152:155]
    s_waitcnt vmcnt(9)
    v_mfma_f32_16x16x32_bf16 v[152:155], v[8:11], v[192:195], v[152:155]
    s_waitcnt vmcnt(7)
    v_mfma_f32_16x16x32_bf16 v[152:155], v[8:11], v[196:199], v[152:155]
    s_waitcnt vmcnt(5)
    v_mfma_f32_16x16x32_bf16 v[152:155], v[8:11], v[200:203], v[152:155]
    s_waitcnt vmcnt(3)
    v_mfma_f32_16x16x32_bf16 v[152:155], v[8:11], v[204:207], v[152:155]
    s_waitcnt vmcnt(1)
    v_mfma_f32_16x16x32_bf16 v[152:155], v[8:11], v[208:211], v[152:155]
    s_mov_b32 s43, 992651947
    s_nop 6
    v_mul_f32 v4, s43, v152
    v_lshlrev_b32 v5, 16, v164
    v_and_b32 v6, 0xffff0000, v164
    v_sub_f32 v5, v5, v4
    v_sub_f32 v6, v6, v4
    v_cvt_pk_bf16_f32 v16, v5, v6
    v_lshlrev_b32 v5, 16, v165
    v_and_b32 v6, 0xffff0000, v165
    v_sub_f32 v5, v5, v4
    v_sub_f32 v6, v6, v4
    v_cvt_pk_bf16_f32 v17, v5, v6
    v_lshlrev_b32 v5, 16, v166
    v_and_b32 v6, 0xffff0000, v166
    v_sub_f32 v5, v5, v4
    v_sub_f32 v6, v6, v4
    v_cvt_pk_bf16_f32 v18, v5, v6
    v_lshlrev_b32 v5, 16, v167
    v_and_b32 v6, 0xffff0000, v167
    v_sub_f32 v5, v5, v4
    v_sub_f32 v6, v6, v4
    v_cvt_pk_bf16_f32 v20, v5, v6
    v_lshlrev_b32 v5, 16, v168
    v_and_b32 v6, 0xffff0000, v168
    v_sub_f32 v5, v5, v4
    v_sub_f32 v6, v6, v4
    v_cvt_pk_bf16_f32 v21, v5, v6
    v_lshlrev_b32 v5, 16, v169
    v_and_b32 v6, 0xffff0000, v169
    v_sub_f32 v5, v5, v4
    v_sub_f32 v6, v6, v4
    v_cvt_pk_bf16_f32 v22, v5, v6
    v_lshlrev_b32 v5, 16, v170
    v_and_b32 v6, 0xffff0000, v170
    v_sub_f32 v5, v5, v4
    v_sub_f32 v6, v6, v4
    v_cvt_pk_bf16_f32 v24, v5, v6
    v_lshlrev_b32 v5, 16, v171
    v_and_b32 v6, 0xffff0000, v171
    v_sub_f32 v5, v5, v4
    v_sub_f32 v6, v6, v4
    v_cvt_pk_bf16_f32 v25, v5, v6
    v_lshlrev_b32 v5, 16, v172
    v_and_b32 v6, 0xffff0000, v172
    v_sub_f32 v5, v5, v4
    v_sub_f32 v6, v6, v4
    v_cvt_pk_bf16_f32 v26, v5, v6
    v_lshlrev_b32 v5, 16, v173
    v_and_b32 v6, 0xffff0000, v173
    v_sub_f32 v5, v5, v4
    v_sub_f32 v6, v6, v4
    v_cvt_pk_bf16_f32 v28, v5, v6
    v_lshlrev_b32 v5, 16, v174
    v_and_b32 v6, 0xffff0000, v174
    v_sub_f32 v5, v5, v4
    v_sub_f32 v6, v6, v4
    v_cvt_pk_bf16_f32 v29, v5, v6
    v_lshlrev_b32 v5, 16, v175
    v_and_b32 v6, 0xffff0000, v175
    v_sub_f32 v5, v5, v4
    v_sub_f32 v6, v6, v4
    v_cvt_pk_bf16_f32 v30, v5, v6
    v_lshlrev_b32 v5, 16, v176
    v_and_b32 v6, 0xffff0000, v176
    v_sub_f32 v5, v5, v4
    v_sub_f32 v6, v6, v4
    v_cvt_pk_bf16_f32 v32, v5, v6
    v_lshlrev_b32 v5, 16, v177
    v_and_b32 v6, 0xffff0000, v177
    v_sub_f32 v5, v5, v4
    v_sub_f32 v6, v6, v4
    v_cvt_pk_bf16_f32 v33, v5, v6
    v_lshlrev_b32 v5, 16, v178
    v_and_b32 v6, 0xffff0000, v178
    v_sub_f32 v5, v5, v4
    v_sub_f32 v6, v6, v4
    v_cvt_pk_bf16_f32 v34, v5, v6
    v_lshlrev_b32 v5, 16, v179
    v_and_b32 v6, 0xffff0000, v179
    v_sub_f32 v5, v5, v4
    v_sub_f32 v6, v6, v4
    v_cvt_pk_bf16_f32 v36, v5, v6
    v_lshlrev_b32 v5, 16, v180
    v_and_b32 v6, 0xffff0000, v180
    v_sub_f32 v5, v5, v4
    v_sub_f32 v6, v6, v4
    v_cvt_pk_bf16_f32 v37, v5, v6
    v_lshlrev_b32 v5, 16, v181
    v_and_b32 v6, 0xffff0000, v181
    v_sub_f32 v5, v5, v4
    v_sub_f32 v6, v6, v4
    v_cvt_pk_bf16_f32 v38, v5, v6
    v_lshlrev_b32 v5, 16, v182
    v_and_b32 v6, 0xffff0000, v182
    v_sub_f32 v5, v5, v4
    v_sub_f32 v6, v6, v4
    v_cvt_pk_bf16_f32 v40, v5, v6
    v_lshlrev_b32 v5, 16, v183
    v_and_b32 v6, 0xffff0000, v183
    v_sub_f32 v5, v5, v4
    v_sub_f32 v6, v6, v4
    v_cvt_pk_bf16_f32 v41, v5, v6
    v_lshlrev_b32 v5, 16, v184
    v_and_b32 v6, 0xffff0000, v184
    v_sub_f32 v5, v5, v4
    v_sub_f32 v6, v6, v4
    v_cvt_pk_bf16_f32 v42, v5, v6
    v_lshlrev_b32 v5, 16, v185
    v_and_b32 v6, 0xffff0000, v185
    v_sub_f32 v5, v5, v4
    v_sub_f32 v6, v6, v4
    v_cvt_pk_bf16_f32 v44, v5, v6
    v_lshlrev_b32 v5, 16, v186
    v_and_b32 v6, 0xffff0000, v186
    v_sub_f32 v5, v5, v4
    v_sub_f32 v6, v6, v4
    v_cvt_pk_bf16_f32 v45, v5, v6
    v_lshlrev_b32 v5, 16, v187
    v_and_b32 v6, 0xffff0000, v187
    v_sub_f32 v5, v5, v4
    v_sub_f32 v6, v6, v4
    v_cvt_pk_bf16_f32 v46, v5, v6
    v_lshlrev_b32 v5, 16, v188
    v_and_b32 v6, 0xffff0000, v188
    v_sub_f32 v5, v5, v4
    v_sub_f32 v6, v6, v4
    v_cvt_pk_bf16_f32 v48, v5, v6
    v_lshlrev_b32 v5, 16, v189
    v_and_b32 v6, 0xffff0000, v189
    v_sub_f32 v5, v5, v4
    v_sub_f32 v6, v6, v4
    v_cvt_pk_bf16_f32 v49, v5, v6
    v_lshlrev_b32 v5, 16, v190
    v_and_b32 v6, 0xffff0000, v190
    v_sub_f32 v5, v5, v4
    v_sub_f32 v6, v6, v4
    v_cvt_pk_bf16_f32 v50, v5, v6
    v_lshlrev_b32 v5, 16, v191
    v_and_b32 v6, 0xffff0000, v191
    v_sub_f32 v5, v5, v4
    v_sub_f32 v6, v6, v4
    v_cvt_pk_bf16_f32 v52, v5, v6
    v_lshlrev_b32 v5, 16, v192
    v_and_b32 v6, 0xffff0000, v192
    v_sub_f32 v5, v5, v4
    v_sub_f32 v6, v6, v4
    v_cvt_pk_bf16_f32 v53, v5, v6
    v_lshlrev_b32 v5, 16, v193
    v_and_b32 v6, 0xffff0000, v193
    v_sub_f32 v5, v5, v4
    v_sub_f32 v6, v6, v4
    v_cvt_pk_bf16_f32 v54, v5, v6
    v_lshlrev_b32 v5, 16, v194
    v_and_b32 v6, 0xffff0000, v194
    v_sub_f32 v5, v5, v4
    v_sub_f32 v6, v6, v4
    v_cvt_pk_bf16_f32 v56, v5, v6
    v_lshlrev_b32 v5, 16, v195
    v_and_b32 v6, 0xffff0000, v195
    v_sub_f32 v5, v5, v4
    v_sub_f32 v6, v6, v4
    v_cvt_pk_bf16_f32 v57, v5, v6
    v_lshlrev_b32 v5, 16, v196
    v_and_b32 v6, 0xffff0000, v196
    v_sub_f32 v5, v5, v4
    v_sub_f32 v6, v6, v4
    v_cvt_pk_bf16_f32 v58, v5, v6
    v_lshlrev_b32 v5, 16, v197
    v_and_b32 v6, 0xffff0000, v197
    v_sub_f32 v5, v5, v4
    v_sub_f32 v6, v6, v4
    v_cvt_pk_bf16_f32 v60, v5, v6
    v_lshlrev_b32 v5, 16, v198
    v_and_b32 v6, 0xffff0000, v198
    v_sub_f32 v5, v5, v4
    v_sub_f32 v6, v6, v4
    v_cvt_pk_bf16_f32 v61, v5, v6
    v_lshlrev_b32 v5, 16, v199
    v_and_b32 v6, 0xffff0000, v199
    v_sub_f32 v5, v5, v4
    v_sub_f32 v6, v6, v4
    v_cvt_pk_bf16_f32 v62, v5, v6
    v_lshlrev_b32 v5, 16, v200
    v_and_b32 v6, 0xffff0000, v200
    v_sub_f32 v5, v5, v4
    v_sub_f32 v6, v6, v4
    v_cvt_pk_bf16_f32 v64, v5, v6
    v_lshlrev_b32 v5, 16, v201
    v_and_b32 v6, 0xffff0000, v201
    v_sub_f32 v5, v5, v4
    v_sub_f32 v6, v6, v4
    v_cvt_pk_bf16_f32 v65, v5, v6
    v_lshlrev_b32 v5, 16, v202
    v_and_b32 v6, 0xffff0000, v202
    v_sub_f32 v5, v5, v4
    v_sub_f32 v6, v6, v4
    v_cvt_pk_bf16_f32 v66, v5, v6
    v_lshlrev_b32 v5, 16, v203
    v_and_b32 v6, 0xffff0000, v203
    v_sub_f32 v5, v5, v4
    v_sub_f32 v6, v6, v4
    v_cvt_pk_bf16_f32 v68, v5, v6
    v_lshlrev_b32 v5, 16, v204
    v_and_b32 v6, 0xffff0000, v204
    v_sub_f32 v5, v5, v4
    v_sub_f32 v6, v6, v4
    v_cvt_pk_bf16_f32 v69, v5, v6
    v_lshlrev_b32 v5, 16, v205
    v_and_b32 v6, 0xffff0000, v205
    v_sub_f32 v5, v5, v4
    v_sub_f32 v6, v6, v4
    v_cvt_pk_bf16_f32 v70, v5, v6
    v_lshlrev_b32 v5, 16, v206
    v_and_b32 v6, 0xffff0000, v206
    v_sub_f32 v5, v5, v4
    v_sub_f32 v6, v6, v4
    v_cvt_pk_bf16_f32 v72, v5, v6
    v_lshlrev_b32 v5, 16, v207
    v_and_b32 v6, 0xffff0000, v207
    v_sub_f32 v5, v5, v4
    v_sub_f32 v6, v6, v4
    v_cvt_pk_bf16_f32 v73, v5, v6
    v_lshlrev_b32 v5, 16, v208
    v_and_b32 v6, 0xffff0000, v208
    v_sub_f32 v5, v5, v4
    v_sub_f32 v6, v6, v4
    v_cvt_pk_bf16_f32 v74, v5, v6
    v_lshlrev_b32 v5, 16, v209
    v_and_b32 v6, 0xffff0000, v209
    v_sub_f32 v5, v5, v4
    v_sub_f32 v6, v6, v4
    v_cvt_pk_bf16_f32 v76, v5, v6
    v_lshlrev_b32 v5, 16, v210
    v_and_b32 v6, 0xffff0000, v210
    v_sub_f32 v5, v5, v4
    v_sub_f32 v6, v6, v4
    v_cvt_pk_bf16_f32 v77, v5, v6
    v_lshlrev_b32 v5, 16, v211
    v_and_b32 v6, 0xffff0000, v211
    v_sub_f32 v5, v5, v4
    v_sub_f32 v6, v6, v4
    v_cvt_pk_bf16_f32 v78, v5, v6
    s_waitcnt vmcnt(0)
    v_lshlrev_b32 v156, 16, v144
    v_and_b32 v157, 0xffff0000, v144
    v_lshlrev_b32 v158, 16, v145
    v_and_b32 v159, 0xffff0000, v145
L_spin_198:
    ds_read_b32 v4, v15 offset:96
    s_waitcnt lgkmcnt(0)
    v_readfirstlane_b32 s61, v4
    s_nop 0
    s_cmp_ge_u32 s61, 2
    s_cbranch_scc0 L_retry_200
L_done_199:
    s_sleep 20
    s_mov_b32 s44, 36864
    s_mov_b32 s45, 40960
    s_mov_b32 s46, 45056
    s_mov_b32 s47, 49152
    v_and_b32 v3, 15, v0
    v_lshlrev_b32 v3, 4, v3
    s_mov_b32 s48, 491520
L_fin_201:
    buffer_load_dwordx4 v[12:15], v3, s[32:35], s48 offen offset:0 sc1
    buffer_load_dwordx4 v[80:83], v1, s[32:35], s44 offen offset:0 sc1
    buffer_load_dwordx4 v[84:87], v1, s[32:35], s44 offen offset:1024 sc1
    buffer_load_dwordx4 v[88:91], v1, s[32:35], s44 offen offset:2048 sc1
    buffer_load_dwordx4 v[92:95], v1, s[32:35], s44 offen offset:3072 sc1
    buffer_load_dwordx4 v[96:99], v1, s[32:35], s45 offen offset:0 sc1
    buffer_load_dwordx4 v[100:103], v1, s[32:35], s45 offen offset:1024 sc1
    buffer_load_dwordx4 v[104:107], v1, s[32:35], s45 offen offset:2048 sc1
    buffer_load_dwordx4 v[108:111], v1, s[32:35], s45 offen offset:3072 sc1
    buffer_load_dwordx4 v[112:115], v1, s[32:35], s46 offen offset:0 sc1
    buffer_load_dwordx4 v[116:119], v1, s[32:35], s46 offen offset:1024 sc1
    buffer_load_dwordx4 v[120:123], v1, s[32:35], s46 offen offset:2048 sc1
    buffer_load_dwordx4 v[124:127], v1, s[32:35], s46 offen offset:3072 sc1
    buffer_load_dwordx4 v[128:131], v1, s[32:35], s47 offen offset:0 sc1
    buffer_load_dwordx4 v[132:135], v1, s[32:35], s47 offen offset:1024 sc1
    buffer_load_dwordx4 v[136:139], v1, s[32:35], s47 offen offset:2048 sc1
    buffer_load_dwordx4 v[140:143], v1, s[32:35], s47 offen offset:3072 sc1
    s_waitcnt vmcnt(16)
    v_bitop3_b32 v4, v12, v13, v14 bitop3:0x96
    v_xor_b32 v4, v4, v15
    v_xor_b32 v5, s54, v4
    v_rcp_f32 v6, v12
    s_waitcnt vmcnt(15)
    v_bitop3_b32 v4, v80, v81, v82 bitop3:0x96
    v_xor_b32 v4, v4, v83
    v_bitop3_b32 v5, v4, v5, s54 bitop3:0xde
    v_mov_b32 v83, 0
    s_waitcnt vmcnt(14)
    v_bitop3_b32 v4, v84, v85, v86 bitop3:0x96
    v_xor_b32 v4, v4, v87
    v_bitop3_b32 v5, v4, v5, s54 bitop3:0xde
    v_mov_b32 v87, 0
    v_mfma_f32_16x16x32_bf16 v[148:151], v[16:19], v[80:83], 0
    s_waitcnt vmcnt(13)
    v_bitop3_b32 v4, v88, v89, v90 bitop3:0x96
    v_xor_b32 v4, v4, v91
    v_bitop3_b32 v5, v4, v5, s54 bitop3:0xde
    v_mov_b32 v91, 0
    v_mfma_f32_16x16x32_bf16 v[148:151], v[20:23], v[84:87], v[148:151]
    s_waitcnt vmcnt(12)
    v_bitop3_b32 v4, v92, v93, v94 bitop3:0x96
    v_xor_b32 v4, v4, v95
    v_bitop3_b32 v5, v4, v5, s54 bitop3:0xde
    v_mov_b32 v95, 0
    v_mfma_f32_16x16x32_bf16 v[148:151], v[24:27], v[88:91], v[148:151]
    s_waitcnt vmcnt(11)
    v_bitop3_b32 v4, v96, v97, v98 bitop3:0x96
    v_xor_b32 v4, v4, v99
    v_bitop3_b32 v5, v4, v5, s54 bitop3:0xde
    v_mov_b32 v99, 0
    v_mfma_f32_16x16x32_bf16 v[148:151], v[28:31], v[92:95], v[148:151]
    s_waitcnt vmcnt(10)
    v_bitop3_b32 v4, v100, v101, v102 bitop3:0x96
    v_xor_b32 v4, v4, v103
    v_bitop3_b32 v5, v4, v5, s54 bitop3:0xde
    v_mov_b32 v103, 0
    v_mfma_f32_16x16x32_bf16 v[148:151], v[32:35], v[96:99], v[148:151]
    s_waitcnt vmcnt(9)
    v_bitop3_b32 v4, v104, v105, v106 bitop3:0x96
    v_xor_b32 v4, v4, v107
    v_bitop3_b32 v5, v4, v5, s54 bitop3:0xde
    v_mov_b32 v107, 0
    v_mfma_f32_16x16x32_bf16 v[148:151], v[36:39], v[100:103], v[148:151]
    s_waitcnt vmcnt(8)
    v_bitop3_b32 v4, v108, v109, v110 bitop3:0x96
    v_xor_b32 v4, v4, v111
    v_bitop3_b32 v5, v4, v5, s54 bitop3:0xde
    v_mov_b32 v111, 0
    v_mfma_f32_16x16x32_bf16 v[148:151], v[40:43], v[104:107], v[148:151]
    s_waitcnt vmcnt(7)
    v_bitop3_b32 v4, v112, v113, v114 bitop3:0x96
    v_xor_b32 v4, v4, v115
    v_bitop3_b32 v5, v4, v5, s54 bitop3:0xde
    v_mov_b32 v115, 0
    v_mfma_f32_16x16x32_bf16 v[148:151], v[44:47], v[108:111], v[148:151]
    s_waitcnt vmcnt(6)
    v_bitop3_b32 v4, v116, v117, v118 bitop3:0x96
    v_xor_b32 v4, v4, v119
    v_bitop3_b32 v5, v4, v5, s54 bitop3:0xde
    v_mov_b32 v119, 0
    v_mfma_f32_16x16x32_bf16 v[148:151], v[48:51], v[112:115], v[148:151]
    s_waitcnt vmcnt(5)
    v_bitop3_b32 v4, v120, v121, v122 bitop3:0x96
    v_xor_b32 v4, v4, v123
    v_bitop3_b32 v5, v4, v5, s54 bitop3:0xde
    v_mov_b32 v123, 0
    v_mfma_f32_16x16x32_bf16 v[148:151], v[52:55], v[116:119], v[148:151]
    s_waitcnt vmcnt(4)
    v_bitop3_b32 v4, v124, v125, v126 bitop3:0x96
    v_xor_b32 v4, v4, v127
    v_bitop3_b32 v5, v4, v5, s54 bitop3:0xde
    v_mov_b32 v127, 0
    v_mfma_f32_16x16x32_bf16 v[148:151], v[56:59], v[120:123], v[148:151]
    s_waitcnt vmcnt(3)
    v_bitop3_b32 v4, v128, v129, v130 bitop3:0x96
    v_xor_b32 v4, v4, v131
    v_bitop3_b32 v5, v4, v5, s54 bitop3:0xde
    v_mov_b32 v131, 0
    v_mfma_f32_16x16x32_bf16 v[148:151], v[60:63], v[124:127], v[148:151]
    s_waitcnt vmcnt(2)
    v_bitop3_b32 v4, v132, v133, v134 bitop3:0x96
    v_xor_b32 v4, v4, v135
    v_bitop3_b32 v5, v4, v5, s54 bitop3:0xde
    v_mov_b32 v135, 0
    v_mfma_f32_16x16x32_bf16 v[148:151], v[64:67], v[128:131], v[148:151]
    s_waitcnt vmcnt(1)
    v_bitop3_b32 v4, v136, v137, v138 bitop3:0x96
    v_xor_b32 v4, v4, v139
    v_bitop3_b32 v5, v4, v5, s54 bitop3:0xde
    v_mov_b32 v139, 0
    v_mfma_f32_16x16x32_bf16 v[148:151], v[68:71], v[132:135], v[148:151]
    s_waitcnt vmcnt(0)
    v_bitop3_b32 v4, v140, v141, v142 bitop3:0x96
    v_xor_b32 v4, v4, v143
    v_bitop3_b32 v5, v4, v5, s54 bitop3:0xde
    v_mov_b32 v143, 0
    v_mfma_f32_16x16x32_bf16 v[148:151], v[72:75], v[136:139], v[148:151]
    s_nop 0
    v_mfma_f32_16x16x32_bf16 v[148:151], v[76:79], v[140:143], v[148:151]
    v_cmp_ne_u32 vcc, 0, v5
    s_nop 0
    s_cbranch_vccz L_find_202
    s_sub_u32 s55, s55, 1
    s_cbranch_scc0 L_fin_201
    s_mov_b32 s55, 0
L_find_202:
    v_mov_b32 v12, v6
    s_nop 0
    v_fma_f32 v148, v148, v12, v156
    v_fma_f32 v149, v149, v12, v157
    v_fma_f32 v150, v150, v12, v158
    v_fma_f32 v151, v151, v12, v159
    v_cvt_pk_bf16_f32 v160, v148, v149
    v_cvt_pk_bf16_f32 v161, v150, v151
    buffer_store_dwordx2 v[160:161], v2, s[56:59], s42 offen
    s_cmp_lg_u32 s40, 0
    s_cbranch_scc1 L_noepoch_203
    v_mov_b32 v4, s54
    v_mov_b32 v5, 0
    s_mov_b64 exec, 1
    buffer_store_dword v4, v5, s[32:35], 0 offen offset:0
    s_mov_b64 exec, -1
L_noepoch_203:
L_nofinal_195:
L_main_end:
    s_endpgm
L_retry_155:
    s_sub_u32 s62, s62, 1
    s_cbranch_scc0 L_spin_153
    s_mov_b32 s62, 0
    s_branch L_done_154
L_retry_158:
    s_sub_u32 s62, s62, 1
    s_cbranch_scc0 L_spin_156
    s_mov_b32 s62, 0
    s_branch L_done_157
L_retry_161:
    s_sub_u32 s62, s62, 1
    s_cbranch_scc0 L_spin_159
    s_mov_b32 s62, 0
    s_branch L_done_160
L_retry_164:
    s_sub_u32 s62, s62, 1
    s_cbranch_scc0 L_spin_162
    s_mov_b32 s62, 0
    s_branch L_done_163
L_retry_169:
    s_sub_u32 s62, s62, 1
    s_cbranch_scc0 L_spin_167
    s_mov_b32 s62, 0
    s_branch L_done_168
L_retry_172:
    s_sub_u32 s62, s62, 1
    s_cbranch_scc0 L_spin_170
    s_mov_b32 s62, 0
    s_branch L_done_171
L_retry_175:
    s_sub_u32 s62, s62, 1
    s_cbranch_scc0 L_spin_173
    s_mov_b32 s62, 0
    s_branch L_done_174
L_retry_178:
    s_sub_u32 s62, s62, 1
    s_cbranch_scc0 L_spin_176
    s_mov_b32 s62, 0
    s_branch L_done_177
L_retry_183:
    s_sub_u32 s62, s62, 1
    s_cbranch_scc0 L_spin_181
    s_mov_b32 s62, 0
    s_branch L_done_182
L_retry_186:
    s_sub_u32 s62, s62, 1
    s_cbranch_scc0 L_spin_184
    s_mov_b32 s62, 0
    s_branch L_done_185
L_retry_189:
    s_sub_u32 s62, s62, 1
    s_cbranch_scc0 L_spin_187
    s_mov_b32 s62, 0
    s_branch L_done_188
L_retry_192:
    s_sub_u32 s62, s62, 1
    s_cbranch_scc0 L_spin_190
    s_mov_b32 s62, 0
    s_branch L_done_191
L_retry_200:
    s_sub_u32 s62, s62, 1
    s_cbranch_scc0 L_spin_198
    s_mov_b32 s62, 0
    s_branch L_done_199
L_code_end:
.section .rodata,"a"
.p2align 6
.amdhsa_kernel standalone__detection_seg_dino__vision_kernel
  .amdhsa_next_free_vgpr 256
  .amdhsa_next_free_sgpr 102
  .amdhsa_accum_offset 256
  .amdhsa_group_segment_fixed_size 0
  .amdhsa_kernarg_size 80
  .amdhsa_user_sgpr_count 2
  .amdhsa_user_sgpr_kernarg_segment_ptr 1
  .amdhsa_system_sgpr_workgroup_id_x 1
  .amdhsa_float_denorm_mode_32 3
.end_amdhsa_kernel
```
